```python
import torch

def _softmax(x, axis=-1):
    return torch.softmax(x, dim=axis)
def _gelu(x):
    return torch.nn.functional.gelu(x, approximate="tanh")
def _silu(x):
    return torch.nn.functional.silu(x)
def _sigmoid(x):
    return torch.sigmoid(x)
def _layernorm(x, axis=-1, eps=1e-5):
    m = x.mean(dim=axis, keepdim=True)
    v = x.var(dim=axis, keepdim=True, unbiased=False)
    return (x - m) / torch.sqrt(v + eps)
def _scatter_add(tgt, idx, src, axis=0):
    return tgt.clone().index_add_(axis, idx, src)
def _segment_sum(src, seg, n):
    out = torch.zeros((n,) + src.shape[1:], dtype=src.dtype)
    return out.index_add_(0, seg, src)
def _pad(x, pw):
    flat = tuple(v for pair in reversed(pw) for v in pair)
    return torch.nn.functional.pad(x, flat)

kernel_name = 'parallel_sum__grouped_kv_mqa__glu_gated_glu__prompt'

def setup_inputs():

    _w = (lambda a: (lambda t: t.to(torch.bfloat16) if t.is_floating_point() else t)(torch.as_tensor(a)))
    def _A_setup():
        B, S, D, H = 1, 2048, 448, 16
        Dh = D // H
        return {
            "x": _w((lambda *s: torch.randn(*s, dtype=torch.bfloat16) * 0.05)(B, S, D)),
            "wq": _w((lambda *s: torch.randn(*s, dtype=torch.bfloat16) * 0.2)(D, H * Dh)),
            "wk": _w((lambda *s: torch.randn(*s, dtype=torch.bfloat16) * 0.2)(D, Dh)),
            "wv": _w((lambda *s: torch.randn(*s, dtype=torch.bfloat16) * 0.1)(D, Dh)),
            "wo": _w((lambda *s: torch.randn(*s, dtype=torch.bfloat16) * 0.1)(H * Dh, D)),
        }
    _A_in = _A_setup()

    def _B_setup():
        B, S, D, F = 1, 2048, 448, 1792
        return {
            "x": _w((lambda *s: torch.randn(*s, dtype=torch.bfloat16) * 0.05)(B, S, D)),
            "w_gate": _w((lambda *s: torch.randn(*s, dtype=torch.bfloat16) * 0.2)(D, F)),
            "w_up": _w((lambda *s: torch.randn(*s, dtype=torch.bfloat16) * 0.1)(D, F)),
            "w_down": _w((lambda *s: torch.randn(*s, dtype=torch.bfloat16) * 0.1)(F, D)),
        }
    _B_in = _B_setup()

    return {
        "A_x": _A_in["x"],
        "A_wq": _A_in["wq"],
        "A_wk": _A_in["wk"],
        "A_wv": _A_in["wv"],
        "A_wo": _A_in["wo"],
        "B_x": _B_in["x"],
        "B_w_gate": _B_in["w_gate"],
        "B_w_up": _B_in["w_up"],
        "B_w_down": _B_in["w_down"],
    }

def reference(A_x, A_wq, A_wk, A_wv, A_wo, B_x, B_w_gate, B_w_up, B_w_down):
    def _A_ref(x, wq, wk, wv, wo):
        B, S, D = x.shape
        H = 16
        Dh = D // H
        q = (lambda x, *d: x.permute(*d))((x @ wq).reshape(B, S, H, Dh), 0, 2, 1, 3)
        k = x @ wk
        v = x @ wv
        scores = torch.einsum("bhqd,bkd->bhqk", q, k) * (Dh ** -0.5)
        p = _softmax(scores, axis=-1)
        o = torch.einsum("bhqk,bkd->bhqd", p, v)
        return (lambda x, *d: x.permute(*d))(o, 0, 2, 1, 3).reshape(B, S, H * Dh) @ wo

    def _B_ref(x, w_gate, w_up, w_down):
        g = torch.einsum("bsd,df->bsf", x, w_gate)
        u = torch.einsum("bsd,df->bsf", x, w_up)
        h = _sigmoid(g) * u
        return torch.einsum("bsf,fd->bsd", h, w_down)

    x = A_x
    xn = _layernorm(x, axis=-1)
    return x + _A_ref(xn, A_wq, A_wk, A_wv, A_wo) + _B_ref(xn, B_w_gate, B_w_up, B_w_down)
```

```asm
; @launch kernel=k1_kernel grid=(256,1,1) block=(512,1,1) lds=155648
; @launch kernel=k2_kernel grid=(256,1,1) block=(256,1,1) lds=102656
.amdgcn_target "amdgcn-amd-amdhsa--gfx950"
.text
.globl k1_kernel
.p2align 8
.type k1_kernel,@function
k1_kernel:
    s_cmp_ge_u32 s2, 256
    s_cbranch_scc1 k1_done
    s_load_dwordx8 s[8:15], s[0:1], 0
    s_load_dwordx4 s[20:23], s[0:1], 48
    s_load_dwordx2 s[16:17], s[0:1], 32
    s_load_dwordx2 s[18:19], s[0:1], 64
    s_load_dwordx2 s[24:25], s[0:1], 88
    s_load_dwordx2 s[80:81], s[0:1], 72
    v_readfirstlane_b32 s3, v0
    v_and_b32 v0, 63, v0
    s_and_b32 s4, s2, 7
    s_lshr_b32 s5, s2, 3
    s_lshr_b32 s3, s3, 6
    s_and_b32 s6, s4, 1
    s_lshl_b32 s6, s6, 3
    s_and_b32 s7, s5, 7
    s_add_u32 s6, s6, s7
    s_lshr_b32 s44, s4, 2
    s_bfe_u32 s45, s4, 0x10001
    s_mul_i32 s46, s44, 7
    s_lshl_b32 s47, s45, 2
    s_add_u32 s47, s47, s46
    s_add_u32 s46, s46, 3
    s_add_u32 s44, s44, 14
    s_lshr_b32 s7, s7, 2
    s_cmp_eq_u32 s7, s45
    s_cselect_b32 s46, s46, s44
    s_lshr_b32 s5, s5, 3
    s_add_u32 s47, s47, s5
    s_sub_u32 s47, s47, 1
    s_cmp_eq_u32 s5, 0
    s_cselect_b32 s7, s46, s47
    s_lshr_b32 s44, s3, 2
    s_and_b32 s45, s3, 3
    s_and_b32 s46, s3, 1
    s_lshr_b32 s47, s3, 1
    s_lshl_b32 s48, s46, 1
    s_xor_b32 s48, s47, s48
    v_lshrrev_b32 v1, 4, v0
    v_bfe_u32 v2, v0, 2, 2
    v_and_b32 v3, 3, v0
    v_xor_b32 v4, v2, v1
    v_lshrrev_b32 v5, 5, v0
    v_and_b32 v6, 31, v0
    s_lshl_b32 s49, s3, 4
    v_lshrrev_b32 v7, 3, v0
    v_add_u32 v7, s49, v7
    v_mul_u32_u24 v8, 896, v7
    v_and_b32 v10, 7, v0
    v_xor_b32 v11, v10, v1
    v_lshl_add_u32 v8, v11, 4, v8
    v_xor_b32 v9, 64, v8
    v_add_u32 v9, 7168, v9
    s_lshl_b32 s50, s7, 8
    s_sub_u32 s51, s7, 14
    s_lshl_b32 s51, s51, 9
    s_lshl_b32 s52, s44, 8
    s_add_u32 s51, s51, s52
    s_cmp_lt_u32 s7, 14
    s_movk_i32 s53, 896
    s_cselect_b32 s53, 3584, s53
    s_cselect_b32 s50, s50, s51
    s_lshl_b32 s57, s7, 1
    s_add_u32 s57, s57, s44
    s_cmp_eq_u32 s57, 31
    s_cselect_b32 s57, 2, 100
    v_mov_b32 v13, s53
    v_lshlrev_b32 v20, 6, v4
    v_add_u32 v20, s50, v20
    v_cmp_le_u32 vcc, s57, v4
    v_mov_b32 v17, 0
    v_mov_b32 v19, 0
    v_mov_b32 v21, 56
    v_cndmask_b32 v13, v13, v21, vcc
    v_cndmask_b32 v20, v20, v17, vcc
    s_lshl_b32 s58, s45, 4
    v_add_u32 v21, s58, v1
    v_mul_lo_u32 v21, v21, v13
    v_add_u32 v20, v20, v21
    v_lshl_add_u32 v16, v3, 4, v20
    v_cmp_eq_u32 s[70:71], s57, v4
    s_mul_i32 s59, s6, 114688
    s_lshl_b32 s60, s3, 11
    s_mul_i32 s61, s45, 24576
    s_lshl_b32 s62, s44, 12
    s_add_u32 s61, s61, s62
    s_add_u32 s61, s61, 49152
    s_waitcnt lgkmcnt(0)
    s_cmp_eq_u32 s44, 0
    s_cselect_b32 s32, s20, s22
    s_cselect_b32 s33, s21, s23
    s_cmp_lt_u32 s7, 14
    s_cselect_b32 s32, s32, s10
    s_cselect_b32 s33, s33, s11
    v_mov_b32 v14, s32
    v_mov_b32 v15, s33
    v_mov_b32 v21, s14
    v_mov_b32 v22, s15
    v_cndmask_b32 v14, v14, v21, vcc
    v_cndmask_b32 v15, v15, v22, vcc
    v_mov_b32 v21, s12
    v_mov_b32 v22, s13
    v_cndmask_b32 v14, v14, v21, s[70:71]
    v_cndmask_b32 v15, v15, v22, s[70:71]
    v_lshl_add_u64 v[14:15], v[16:17], 0, v[14:15]
    v_lshlrev_b32 v16, 2, v13
    v_mul_u32_u24 v18, 52, v13
    s_mov_b32 s28, s8
    s_and_b32 s29, s9, 0xffff
    s_mov_b32 s30, 0x1c0000
    s_mov_b32 s31, 0x00020000
    s_add_u32 m0, s61, 0
    s_nop 0
    global_load_lds_dwordx4 v[14:15], off
    v_lshl_add_u64 v[14:15], v[16:17], 0, v[14:15]
    s_add_u32 m0, s60, 0
    s_nop 0
    buffer_load_dwordx4 v8, s[28:31], s59 offen lds
    s_add_u32 m0, s61, 1024
    s_nop 0
    global_load_lds_dwordx4 v[14:15], off
    v_lshl_add_u64 v[14:15], v[16:17], 0, v[14:15]
    s_add_u32 m0, s61, 2048
    s_nop 0
    global_load_lds_dwordx4 v[14:15], off
    v_lshl_add_u64 v[14:15], v[16:17], 0, v[14:15]
    s_add_u32 m0, s60, 1024
    s_nop 0
    buffer_load_dwordx4 v9, s[28:31], s59 offen lds
    s_add_u32 s59, s59, 128
    s_add_u32 m0, s61, 3072
    s_nop 0
    global_load_lds_dwordx4 v[14:15], off
    v_lshl_add_u64 v[14:15], v[18:19], 0, v[14:15]
    s_mov_b32 s40, s24
    s_and_b32 s41, s25, 0xffff
    s_mov_b32 s42, 0x1100000
    s_mov_b32 s43, 0x00020000
    s_lshl_b32 s63, s2, 3
    s_add_u32 s63, s63, s3
    s_mul_i32 s64, s63, 4682
    s_lshr_b32 s64, s64, 16
    s_mul_i32 s65, s64, 14
    s_sub_u32 s65, s63, s65
    s_mul_i32 s54, s64, 1821
    s_lshr_b32 s54, s54, 16
    s_mul_i32 s55, s54, 36
    s_sub_u32 s55, s64, s55
    s_lshr_b32 s69, s65, 1
    s_lshl_b32 s69, s69, 2
    s_add_u32 s69, s69, s54
    s_lshl_b32 s69, s69, 3
    s_add_u32 s69, s69, s55
    s_lshl_b32 s69, s69, 1
    s_lshr_b32 s68, s54, 1
    s_xor_b32 s68, s68, s65
    s_and_b32 s68, s68, 1
    s_xor_b32 s68, s68, 1
    s_add_u32 s69, s69, s68
    s_lshl_b32 s69, s69, 10
    s_add_u32 s69, s69, 6496256
    s_mul_i32 s66, s54, 28
    s_add_u32 s66, s66, s55
    s_lshl_b32 s66, s66, 4
    s_sub_u32 s56, s55, 28
    s_lshr_b32 s58, s56, 1
    s_lshl_b32 s54, s54, 2
    s_add_u32 s58, s58, s54
    s_mul_i32 s58, s58, 28
    s_and_b32 s56, s56, 1
    s_lshl_b32 s54, s56, 4
    s_add_u32 s58, s58, s54
    s_lshl_b32 s56, s56, 4
    s_sub_u32 s56, 64, s56
    s_cmp_lt_u32 s55, 28
    s_cselect_b32 s36, s18, s16
    s_cselect_b32 s37, s19, s17
    s_mov_b32 s38, 401408
    s_cselect_b32 s38, 1605632, s38
    s_cselect_b32 s66, s66, s58
    s_cselect_b32 s56, 64, s56
    s_and_b32 s37, s37, 0xffff
    s_mov_b32 s39, 0x00020000
    s_mul_i32 s66, s66, 896
    s_lshl_b32 s67, s65, 6
    s_add_u32 s66, s66, s67
    s_mul_i32 s67, s65, 144
    s_add_u32 s67, s67, s64
    s_lshl_b32 s67, s67, 10
    s_add_u32 s67, s67, 2359296
    s_cmp_lt_u32 s55, 28
    s_cselect_b32 s67, s67, s69
    s_cmp_lt_u32 s63, 2016
    s_cselect_b32 s67, s67, 0x7fff0000
    v_cmp_gt_u32 vcc, s56, v0
    v_lshrrev_b32 v21, 2, v0
    v_mul_u32_u24 v21, 896, v21
    v_lshl_add_u32 v21, v3, 4, v21
    v_mov_b32 v22, 0x7fff0000
    v_cndmask_b32 v21, v22, v21, vcc
    s_lshl_b32 s68, s3, 10
    s_add_u32 s68, s68, 147456
    v_lshlrev_b32 v49, 4, v0
    v_mov_b32 v23, v21
    s_lshl_b32 s26, s63, 10
    s_add_u32 s26, s26, 4456448
    v_mov_b32 v248, -1
    v_mov_b32 v249, -1
    v_mov_b32 v250, -1
    v_mov_b32 v251, -1
    v_bfe_u32 v20, v0, 1, 3
    v_xor_b32 v20, v20, v5
    v_lshlrev_b32 v20, 4, v20
    v_lshl_add_u32 v20, v6, 7, v20
    s_lshl_b32 s62, s46, 13
    v_add_u32 v20, s62, v20
    v_lshl_add_u32 v21, v5, 3, v2
    v_lshlrev_b32 v21, 8, v21
    v_xor_b32 v22, s47, v2
    v_lshl_add_u32 v21, v22, 6, v21
    v_and_b32 v22, 1, v1
    v_lshlrev_b32 v22, 5, v22
    v_lshl_add_u32 v22, v3, 3, v22
    v_add_u32 v21, v21, v22
    v_lshl_add_u32 v32, v5, 2, v2
    v_lshl_add_u32 v32, v32, 6, v22
    v_add_u32 v48, s68, v32
    s_xor_b32 s62, s48, 0
    s_lshl_b32 s69, s62, 5
    v_xor_b32 v24, s69, v20
    s_mul_i32 s62, s62, 24576
    s_add_u32 s62, s62, 49152
    v_add_u32 v28, s62, v21
    s_xor_b32 s62, s48, 1
    s_lshl_b32 s69, s62, 5
    v_xor_b32 v25, s69, v20
    s_mul_i32 s62, s62, 24576
    s_add_u32 s62, s62, 49152
    v_add_u32 v29, s62, v21
    s_xor_b32 s62, s48, 2
    s_lshl_b32 s69, s62, 5
    v_xor_b32 v26, s69, v20
    s_mul_i32 s62, s62, 24576
    s_add_u32 s62, s62, 49152
    v_add_u32 v30, s62, v21
    s_xor_b32 s62, s48, 3
    s_lshl_b32 s69, s62, 5
    v_xor_b32 v27, s69, v20
    s_mul_i32 s62, s62, 24576
    s_add_u32 s62, s62, 49152
    v_add_u32 v31, s62, v21
    v_mov_b32 v36, 0
    v_mov_b32 v37, 0
    v_mov_b32 v38, 0
    v_mov_b32 v39, 0
    v_mov_b32 v33, 0x3f803f80
    v_cmp_eq_u32 vcc, 0, v6
    v_cmp_eq_u32 s[70:71], 20, v6
    s_mov_b32 s72, 0xffff0000
    s_mov_b32 s73, 0x07060302
    s_or_b64 vcc, vcc, s[70:71]
    s_mov_b32 s74, 0x3b124925
    v_cndmask_b32 v168, 0, v33, vcc
    v_mov_b32 v169, v168
    v_mov_b32 v170, v168
    v_mov_b32 v171, v168
    s_lshl_b32 s62, s46, 12
    s_add_u32 s62, s62, 16384
    v_lshlrev_b32 v44, 6, v6
    v_add_u32 v44, s62, v44
    s_lshl_b32 s69, s47, 4
    v_lshl_add_u32 v45, v5, 3, v44
    v_add_u32 v45, s69, v45
    s_lshl_b32 s62, s47, 9
    s_add_u32 s62, s62, 24576
    v_lshlrev_b32 v46, 2, v6
    v_add_u32 v46, s62, v46
    s_lshl_b32 s69, s46, 7
    v_add_u32 v47, s69, v46
    v_cmp_gt_u32 vcc, 32, v0
    s_lshl_b32 s75, s6, 2
    s_lshl_b32 s62, s46, 1
    s_add_u32 s75, s75, s62
    v_mov_b32 v190, 0
    v_mov_b32 v191, 0
    v_mov_b32 v194, 0
    v_mov_b32 v195, 0
    s_add_u32 m0, s61, 8192
    s_nop 0
    global_load_lds_dwordx4 v[14:15], off
    v_lshl_add_u64 v[14:15], v[16:17], 0, v[14:15]
    s_add_u32 m0, s60, 16384
    s_nop 0
    buffer_load_dwordx4 v8, s[28:31], s59 offen lds
    s_add_u32 m0, s61, 9216
    s_nop 0
    global_load_lds_dwordx4 v[14:15], off
    v_lshl_add_u64 v[14:15], v[16:17], 0, v[14:15]
    s_add_u32 m0, s61, 10240
    s_nop 0
    global_load_lds_dwordx4 v[14:15], off
    v_lshl_add_u64 v[14:15], v[16:17], 0, v[14:15]
    s_add_u32 m0, s60, 17408
    s_nop 0
    buffer_load_dwordx4 v9, s[28:31], s59 offen lds
    s_add_u32 s59, s59, 128
    s_add_u32 m0, s61, 11264
    s_nop 0
    global_load_lds_dwordx4 v[14:15], off
    v_lshl_add_u64 v[14:15], v[18:19], 0, v[14:15]
    s_mov_b32 m0, s68
    s_nop 0
    buffer_load_dwordx4 v23, s[36:39], s66 offen lds
    s_waitcnt vmcnt(7)
    s_barrier
    ds_read_b64_tr_b16 v[136:137], v28 offset:0
    ds_read_b64_tr_b16 v[138:139], v28 offset:1024
    ds_read_b128 v[172:175], v24 offset:0
    ds_read_b64_tr_b16 v[140:141], v28 offset:4096
    ds_read_b64_tr_b16 v[142:143], v28 offset:5120
    ds_read_b128 v[176:179], v24 offset:4096
    s_waitcnt lgkmcnt(0)
    v_mfma_f32_16x16x32_bf16 v[160:163], v[168:171], v[136:139], 0
    ds_read_b64_tr_b16 v[152:153], v29 offset:0
    ds_read_b64_tr_b16 v[154:155], v29 offset:1024
    ds_read_b128 v[144:147], v25 offset:0
    ds_read_b64_tr_b16 v[156:157], v29 offset:4096
    ds_read_b64_tr_b16 v[158:159], v29 offset:5120
    ds_read_b128 v[148:151], v25 offset:4096
    v_and_b32 v40, s72, v172
    v_lshlrev_b32 v41, 16, v172
    v_add_f32 v36, v36, v40
    v_mfma_f32_32x32x16_bf16 v[64:79], v[136:139], v[172:175], 0
    v_fmac_f32 v37, v40, v40
    v_add_f32 v36, v36, v41
    v_fmac_f32 v37, v41, v41
    v_mfma_f32_32x32x16_bf16 v[80:95], v[136:139], v[176:179], 0
    v_and_b32 v42, s72, v173
    v_lshlrev_b32 v43, 16, v173
    v_mfma_f32_16x16x32_bf16 v[164:167], v[168:171], v[140:143], 0
    v_add_f32 v36, v36, v42
    v_fmac_f32 v37, v42, v42
    v_add_f32 v36, v36, v43
    v_mfma_f32_32x32x16_bf16 v[96:111], v[140:143], v[172:175], 0
    s_add_u32 m0, s61, 16384
    s_nop 0
    global_load_lds_dwordx4 v[14:15], off
    v_lshl_add_u64 v[14:15], v[16:17], 0, v[14:15]
    v_fmac_f32 v37, v43, v43
    v_and_b32 v40, s72, v174
    v_lshlrev_b32 v41, 16, v174
    v_mfma_f32_32x32x16_bf16 v[112:127], v[140:143], v[176:179], 0
    s_add_u32 m0, s60, 32768
    s_nop 0
    buffer_load_dwordx4 v8, s[28:31], s59 offen lds
    v_add_f32 v36, v36, v40
    v_fmac_f32 v37, v40, v40
    s_waitcnt lgkmcnt(0)
    v_mfma_f32_16x16x32_bf16 v[160:163], v[168:171], v[152:155], v[160:163]
    ds_read_b64_tr_b16 v[136:137], v30 offset:0
    ds_read_b64_tr_b16 v[138:139], v30 offset:1024
    ds_read_b128 v[128:131], v26 offset:0
    ds_read_b64_tr_b16 v[140:141], v30 offset:4096
    ds_read_b64_tr_b16 v[142:143], v30 offset:5120
    ds_read_b128 v[132:135], v26 offset:4096
    v_add_f32 v36, v36, v41
    v_fmac_f32 v37, v41, v41
    v_and_b32 v42, s72, v175
    v_mfma_f32_32x32x16_bf16 v[64:79], v[152:155], v[144:147], v[64:79]
    v_lshlrev_b32 v43, 16, v175
    v_add_f32 v36, v36, v42
    v_fmac_f32 v37, v42, v42
    v_mfma_f32_32x32x16_bf16 v[80:95], v[152:155], v[148:151], v[80:95]
    v_add_f32 v36, v36, v43
    v_fmac_f32 v37, v43, v43
    v_mfma_f32_16x16x32_bf16 v[164:167], v[168:171], v[156:159], v[164:167]
    v_and_b32 v40, s72, v176
    v_lshlrev_b32 v41, 16, v176
    v_add_f32 v38, v38, v40
    v_mfma_f32_32x32x16_bf16 v[96:111], v[156:159], v[144:147], v[96:111]
    s_add_u32 m0, s61, 17408
    s_nop 0
    global_load_lds_dwordx4 v[14:15], off
    v_lshl_add_u64 v[14:15], v[16:17], 0, v[14:15]
    v_fmac_f32 v39, v40, v40
    v_add_f32 v38, v38, v41
    v_fmac_f32 v39, v41, v41
    v_mfma_f32_32x32x16_bf16 v[112:127], v[156:159], v[148:151], v[112:127]
    s_add_u32 m0, s61, 18432
    s_nop 0
    global_load_lds_dwordx4 v[14:15], off
    v_lshl_add_u64 v[14:15], v[16:17], 0, v[14:15]
    v_and_b32 v42, s72, v177
    v_lshlrev_b32 v43, 16, v177
    s_waitcnt lgkmcnt(0)
    v_mfma_f32_32x32x16_bf16 v[64:79], v[136:139], v[128:131], v[64:79]
    ds_read_b64_tr_b16 v[152:153], v31 offset:0
    ds_read_b64_tr_b16 v[154:155], v31 offset:1024
    ds_read_b128 v[144:147], v27 offset:0
    ds_read_b64_tr_b16 v[156:157], v31 offset:4096
    ds_read_b64_tr_b16 v[158:159], v31 offset:5120
    ds_read_b128 v[148:151], v27 offset:4096
    v_add_f32 v38, v38, v42
    v_fmac_f32 v39, v42, v42
    v_add_f32 v38, v38, v43
    v_fmac_f32 v39, v43, v43
    v_mfma_f32_32x32x16_bf16 v[80:95], v[136:139], v[132:135], v[80:95]
    v_and_b32 v40, s72, v178
    v_lshlrev_b32 v41, 16, v178
    v_add_f32 v38, v38, v40
    v_fmac_f32 v39, v40, v40
    v_mfma_f32_32x32x16_bf16 v[96:111], v[140:143], v[128:131], v[96:111]
    s_add_u32 m0, s60, 33792
    s_nop 0
    buffer_load_dwordx4 v9, s[28:31], s59 offen lds
    s_add_u32 s59, s59, 128
    v_add_f32 v38, v38, v41
    v_fmac_f32 v39, v41, v41
    v_and_b32 v42, s72, v179
    v_lshlrev_b32 v43, 16, v179
    v_mfma_f32_32x32x16_bf16 v[112:127], v[140:143], v[132:135], v[112:127]
    s_add_u32 m0, s61, 19456
    s_nop 0
    global_load_lds_dwordx4 v[14:15], off
    v_lshl_add_u64 v[14:15], v[18:19], 0, v[14:15]
    v_add_f32 v38, v38, v42
    v_fmac_f32 v39, v42, v42
    v_add_f32 v38, v38, v43
    v_fmac_f32 v39, v43, v43
    s_waitcnt vmcnt(7) lgkmcnt(0)
    s_barrier
    v_mfma_f32_32x32x16_bf16 v[64:79], v[152:155], v[144:147], v[64:79]
    ds_read_b64_tr_b16 v[136:137], v28 offset:8192
    ds_read_b64_tr_b16 v[138:139], v28 offset:9216
    ds_read_b128 v[172:175], v24 offset:16384
    ds_read_b64_tr_b16 v[140:141], v28 offset:12288
    ds_read_b64_tr_b16 v[142:143], v28 offset:13312
    ds_read_b128 v[176:179], v24 offset:20480
    v_mfma_f32_32x32x16_bf16 v[80:95], v[152:155], v[148:151], v[80:95]
    v_mfma_f32_32x32x16_bf16 v[96:111], v[156:159], v[144:147], v[96:111]
    s_add_u32 m0, s61, 0
    s_nop 0
    global_load_lds_dwordx4 v[14:15], off
    v_lshl_add_u64 v[14:15], v[16:17], 0, v[14:15]
    v_mfma_f32_32x32x16_bf16 v[112:127], v[156:159], v[148:151], v[112:127]
    s_add_u32 m0, s60, 0
    s_nop 0
    buffer_load_dwordx4 v8, s[28:31], s59 offen lds
    s_waitcnt lgkmcnt(0)
    v_mfma_f32_16x16x32_bf16 v[160:163], v[168:171], v[136:139], v[160:163]
    ds_read_b64_tr_b16 v[152:153], v29 offset:8192
    ds_read_b64_tr_b16 v[154:155], v29 offset:9216
    ds_read_b128 v[144:147], v25 offset:16384
    ds_read_b64_tr_b16 v[156:157], v29 offset:12288
    ds_read_b64_tr_b16 v[158:159], v29 offset:13312
    ds_read_b128 v[148:151], v25 offset:20480
    v_and_b32 v40, s72, v172
    v_lshlrev_b32 v41, 16, v172
    v_add_f32 v36, v36, v40
    v_mfma_f32_32x32x16_bf16 v[64:79], v[136:139], v[172:175], v[64:79]
    v_fmac_f32 v37, v40, v40
    v_add_f32 v36, v36, v41
    v_fmac_f32 v37, v41, v41
    v_mfma_f32_32x32x16_bf16 v[80:95], v[136:139], v[176:179], v[80:95]
    v_and_b32 v42, s72, v173
    v_lshlrev_b32 v43, 16, v173
    v_mfma_f32_16x16x32_bf16 v[164:167], v[168:171], v[140:143], v[164:167]
    v_add_f32 v36, v36, v42
    v_fmac_f32 v37, v42, v42
    v_add_f32 v36, v36, v43
    v_mfma_f32_32x32x16_bf16 v[96:111], v[140:143], v[172:175], v[96:111]
    s_add_u32 m0, s61, 1024
    s_nop 0
    global_load_lds_dwordx4 v[14:15], off
    v_lshl_add_u64 v[14:15], v[16:17], 0, v[14:15]
    v_fmac_f32 v37, v43, v43
    v_and_b32 v40, s72, v174
    v_lshlrev_b32 v41, 16, v174
    v_mfma_f32_32x32x16_bf16 v[112:127], v[140:143], v[176:179], v[112:127]
    s_add_u32 m0, s61, 2048
    s_nop 0
    global_load_lds_dwordx4 v[14:15], off
    v_lshl_add_u64 v[14:15], v[16:17], 0, v[14:15]
    v_add_f32 v36, v36, v40
    v_fmac_f32 v37, v40, v40
    s_waitcnt lgkmcnt(0)
    v_mfma_f32_16x16x32_bf16 v[160:163], v[168:171], v[152:155], v[160:163]
    ds_read_b64_tr_b16 v[136:137], v30 offset:8192
    ds_read_b64_tr_b16 v[138:139], v30 offset:9216
    ds_read_b128 v[128:131], v26 offset:16384
    ds_read_b64_tr_b16 v[140:141], v30 offset:12288
    ds_read_b64_tr_b16 v[142:143], v30 offset:13312
    ds_read_b128 v[132:135], v26 offset:20480
    v_add_f32 v36, v36, v41
    v_fmac_f32 v37, v41, v41
    v_and_b32 v42, s72, v175
    v_mfma_f32_32x32x16_bf16 v[64:79], v[152:155], v[144:147], v[64:79]
    v_lshlrev_b32 v43, 16, v175
    v_add_f32 v36, v36, v42
    v_fmac_f32 v37, v42, v42
    v_mfma_f32_32x32x16_bf16 v[80:95], v[152:155], v[148:151], v[80:95]
    v_add_f32 v36, v36, v43
    v_fmac_f32 v37, v43, v43
    v_mfma_f32_16x16x32_bf16 v[164:167], v[168:171], v[156:159], v[164:167]
    v_and_b32 v40, s72, v176
    v_lshlrev_b32 v41, 16, v176
    v_add_f32 v38, v38, v40
    v_mfma_f32_32x32x16_bf16 v[96:111], v[156:159], v[144:147], v[96:111]
    s_add_u32 m0, s60, 1024
    s_nop 0
    buffer_load_dwordx4 v9, s[28:31], s59 offen lds
    s_add_u32 s59, s59, 128
    v_fmac_f32 v39, v40, v40
    v_add_f32 v38, v38, v41
    v_fmac_f32 v39, v41, v41
    v_mfma_f32_32x32x16_bf16 v[112:127], v[156:159], v[148:151], v[112:127]
    s_add_u32 m0, s61, 3072
    s_nop 0
    global_load_lds_dwordx4 v[14:15], off
    v_lshl_add_u64 v[14:15], v[18:19], 0, v[14:15]
    v_and_b32 v42, s72, v177
    v_lshlrev_b32 v43, 16, v177
    s_waitcnt lgkmcnt(0)
    v_mfma_f32_32x32x16_bf16 v[64:79], v[136:139], v[128:131], v[64:79]
    ds_read_b64_tr_b16 v[152:153], v31 offset:8192
    ds_read_b64_tr_b16 v[154:155], v31 offset:9216
    ds_read_b128 v[144:147], v27 offset:16384
    ds_read_b64_tr_b16 v[156:157], v31 offset:12288
    ds_read_b64_tr_b16 v[158:159], v31 offset:13312
    ds_read_b128 v[148:151], v27 offset:20480
    v_add_f32 v38, v38, v42
    v_fmac_f32 v39, v42, v42
    v_add_f32 v38, v38, v43
    v_fmac_f32 v39, v43, v43
    v_mfma_f32_32x32x16_bf16 v[80:95], v[136:139], v[132:135], v[80:95]
    v_and_b32 v40, s72, v178
    v_lshlrev_b32 v41, 16, v178
    v_add_f32 v38, v38, v40
    v_fmac_f32 v39, v40, v40
    v_mfma_f32_32x32x16_bf16 v[96:111], v[140:143], v[128:131], v[96:111]
    v_add_f32 v38, v38, v41
    v_fmac_f32 v39, v41, v41
    v_and_b32 v42, s72, v179
    v_lshlrev_b32 v43, 16, v179
    v_mfma_f32_32x32x16_bf16 v[112:127], v[140:143], v[132:135], v[112:127]
    v_add_f32 v38, v38, v42
    v_fmac_f32 v39, v42, v42
    v_add_f32 v38, v38, v43
    v_fmac_f32 v39, v43, v43
    s_waitcnt vmcnt(6) lgkmcnt(0)
    s_barrier
    v_mfma_f32_32x32x16_bf16 v[64:79], v[152:155], v[144:147], v[64:79]
    ds_read_b64_tr_b16 v[136:137], v28 offset:16384
    ds_read_b64_tr_b16 v[138:139], v28 offset:17408
    ds_read_b128 v[172:175], v24 offset:32768
    ds_read_b64_tr_b16 v[140:141], v28 offset:20480
    ds_read_b64_tr_b16 v[142:143], v28 offset:21504
    ds_read_b128 v[176:179], v24 offset:36864
    v_mfma_f32_32x32x16_bf16 v[80:95], v[152:155], v[148:151], v[80:95]
    v_mfma_f32_32x32x16_bf16 v[96:111], v[156:159], v[144:147], v[96:111]
    s_add_u32 m0, s61, 8192
    s_nop 0
    global_load_lds_dwordx4 v[14:15], off
    v_lshl_add_u64 v[14:15], v[16:17], 0, v[14:15]
    v_mfma_f32_32x32x16_bf16 v[112:127], v[156:159], v[148:151], v[112:127]
    s_add_u32 m0, s60, 16384
    s_nop 0
    buffer_load_dwordx4 v8, s[28:31], s59 offen lds
    s_waitcnt lgkmcnt(0)
    v_mfma_f32_16x16x32_bf16 v[160:163], v[168:171], v[136:139], v[160:163]
    ds_read_b64_tr_b16 v[152:153], v29 offset:16384
    ds_read_b64_tr_b16 v[154:155], v29 offset:17408
    ds_read_b128 v[144:147], v25 offset:32768
    ds_read_b64_tr_b16 v[156:157], v29 offset:20480
    ds_read_b64_tr_b16 v[158:159], v29 offset:21504
    ds_read_b128 v[148:151], v25 offset:36864
    v_and_b32 v40, s72, v172
    v_lshlrev_b32 v41, 16, v172
    v_add_f32 v36, v36, v40
    v_mfma_f32_32x32x16_bf16 v[64:79], v[136:139], v[172:175], v[64:79]
    v_fmac_f32 v37, v40, v40
    v_add_f32 v36, v36, v41
    v_fmac_f32 v37, v41, v41
    v_mfma_f32_32x32x16_bf16 v[80:95], v[136:139], v[176:179], v[80:95]
    v_and_b32 v42, s72, v173
    v_lshlrev_b32 v43, 16, v173
    v_mfma_f32_16x16x32_bf16 v[164:167], v[168:171], v[140:143], v[164:167]
    v_add_f32 v36, v36, v42
    v_fmac_f32 v37, v42, v42
    v_add_f32 v36, v36, v43
    v_mfma_f32_32x32x16_bf16 v[96:111], v[140:143], v[172:175], v[96:111]
    s_add_u32 m0, s61, 9216
    s_nop 0
    global_load_lds_dwordx4 v[14:15], off
    v_lshl_add_u64 v[14:15], v[16:17], 0, v[14:15]
    v_fmac_f32 v37, v43, v43
    v_and_b32 v40, s72, v174
    v_lshlrev_b32 v41, 16, v174
    v_mfma_f32_32x32x16_bf16 v[112:127], v[140:143], v[176:179], v[112:127]
    s_add_u32 m0, s61, 10240
    s_nop 0
    global_load_lds_dwordx4 v[14:15], off
    v_lshl_add_u64 v[14:15], v[16:17], 0, v[14:15]
    v_add_f32 v36, v36, v40
    v_fmac_f32 v37, v40, v40
    s_waitcnt lgkmcnt(0)
    v_mfma_f32_16x16x32_bf16 v[160:163], v[168:171], v[152:155], v[160:163]
    ds_read_b64_tr_b16 v[136:137], v30 offset:16384
    ds_read_b64_tr_b16 v[138:139], v30 offset:17408
    ds_read_b128 v[128:131], v26 offset:32768
    ds_read_b64_tr_b16 v[140:141], v30 offset:20480
    ds_read_b64_tr_b16 v[142:143], v30 offset:21504
    ds_read_b128 v[132:135], v26 offset:36864
    ds_read_b64_tr_b16 v[228:229], v48
    ds_read_b64_tr_b16 v[230:231], v48 offset:512
    v_add_f32 v36, v36, v41
    v_fmac_f32 v37, v41, v41
    v_and_b32 v42, s72, v175
    v_mfma_f32_32x32x16_bf16 v[64:79], v[152:155], v[144:147], v[64:79]
    v_lshlrev_b32 v43, 16, v175
    v_add_f32 v36, v36, v42
    v_fmac_f32 v37, v42, v42
    v_mfma_f32_32x32x16_bf16 v[80:95], v[152:155], v[148:151], v[80:95]
    v_add_f32 v36, v36, v43
    v_fmac_f32 v37, v43, v43
    v_mfma_f32_16x16x32_bf16 v[164:167], v[168:171], v[156:159], v[164:167]
    v_and_b32 v40, s72, v176
    v_lshlrev_b32 v41, 16, v176
    v_add_f32 v38, v38, v40
    v_mfma_f32_32x32x16_bf16 v[96:111], v[156:159], v[144:147], v[96:111]
    s_add_u32 m0, s60, 17408
    s_nop 0
    buffer_load_dwordx4 v9, s[28:31], s59 offen lds
    s_add_u32 s59, s59, 128
    v_fmac_f32 v39, v40, v40
    v_add_f32 v38, v38, v41
    v_fmac_f32 v39, v41, v41
    v_mfma_f32_32x32x16_bf16 v[112:127], v[156:159], v[148:151], v[112:127]
    s_add_u32 m0, s61, 11264
    s_nop 0
    global_load_lds_dwordx4 v[14:15], off
    v_lshl_add_u64 v[14:15], v[18:19], 0, v[14:15]
    v_and_b32 v42, s72, v177
    v_lshlrev_b32 v43, 16, v177
    s_waitcnt lgkmcnt(0)
    v_mfma_f32_32x32x16_bf16 v[64:79], v[136:139], v[128:131], v[64:79]
    ds_read_b64_tr_b16 v[152:153], v31 offset:16384
    ds_read_b64_tr_b16 v[154:155], v31 offset:17408
    ds_read_b128 v[144:147], v27 offset:32768
    ds_read_b64_tr_b16 v[156:157], v31 offset:20480
    ds_read_b64_tr_b16 v[158:159], v31 offset:21504
    ds_read_b128 v[148:151], v27 offset:36864
    v_add_f32 v38, v38, v42
    v_fmac_f32 v39, v42, v42
    v_add_f32 v38, v38, v43
    v_fmac_f32 v39, v43, v43
    v_mfma_f32_32x32x16_bf16 v[80:95], v[136:139], v[132:135], v[80:95]
    v_and_b32 v40, s72, v178
    v_lshlrev_b32 v41, 16, v178
    v_add_f32 v38, v38, v40
    v_fmac_f32 v39, v40, v40
    v_mfma_f32_32x32x16_bf16 v[96:111], v[140:143], v[128:131], v[96:111]
    v_add_f32 v38, v38, v41
    v_fmac_f32 v39, v41, v41
    v_and_b32 v42, s72, v179
    v_lshlrev_b32 v43, 16, v179
    v_mfma_f32_32x32x16_bf16 v[112:127], v[140:143], v[132:135], v[112:127]
    v_add_f32 v38, v38, v42
    v_fmac_f32 v39, v42, v42
    v_add_f32 v38, v38, v43
    v_fmac_f32 v39, v43, v43
    s_waitcnt vmcnt(6) lgkmcnt(0)
    s_barrier
    v_mfma_f32_32x32x16_bf16 v[64:79], v[152:155], v[144:147], v[64:79]
    ds_read_b64_tr_b16 v[136:137], v28 offset:0
    ds_read_b64_tr_b16 v[138:139], v28 offset:1024
    ds_read_b128 v[172:175], v24 offset:0
    ds_read_b64_tr_b16 v[140:141], v28 offset:4096
    ds_read_b64_tr_b16 v[142:143], v28 offset:5120
    ds_read_b128 v[176:179], v24 offset:4096
    v_mfma_f32_32x32x16_bf16 v[80:95], v[152:155], v[148:151], v[80:95]
    v_mfma_f32_32x32x16_bf16 v[96:111], v[156:159], v[144:147], v[96:111]
    s_add_u32 m0, s61, 16384
    s_nop 0
    global_load_lds_dwordx4 v[14:15], off
    v_lshl_add_u64 v[14:15], v[16:17], 0, v[14:15]
    v_mfma_f32_32x32x16_bf16 v[112:127], v[156:159], v[148:151], v[112:127]
    s_add_u32 m0, s60, 32768
    s_nop 0
    buffer_load_dwordx4 v8, s[28:31], s59 offen lds
    s_waitcnt lgkmcnt(0)
    v_mfma_f32_16x16x32_bf16 v[160:163], v[168:171], v[136:139], v[160:163]
    ds_read_b64_tr_b16 v[152:153], v29 offset:0
    ds_read_b64_tr_b16 v[154:155], v29 offset:1024
    ds_read_b128 v[144:147], v25 offset:0
    ds_read_b64_tr_b16 v[156:157], v29 offset:4096
    ds_read_b64_tr_b16 v[158:159], v29 offset:5120
    ds_read_b128 v[148:151], v25 offset:4096
    v_and_b32 v40, s72, v172
    v_lshlrev_b32 v41, 16, v172
    v_add_f32 v36, v36, v40
    v_mfma_f32_32x32x16_bf16 v[64:79], v[136:139], v[172:175], v[64:79]
    v_fmac_f32 v37, v40, v40
    v_add_f32 v36, v36, v41
    v_fmac_f32 v37, v41, v41
    v_mfma_f32_32x32x16_bf16 v[80:95], v[136:139], v[176:179], v[80:95]
    v_and_b32 v42, s72, v173
    v_lshlrev_b32 v43, 16, v173
    v_mfma_f32_16x16x32_bf16 v[164:167], v[168:171], v[140:143], v[164:167]
    v_add_f32 v36, v36, v42
    v_fmac_f32 v37, v42, v42
    v_add_f32 v36, v36, v43
    v_mfma_f32_32x32x16_bf16 v[96:111], v[140:143], v[172:175], v[96:111]
    s_add_u32 m0, s61, 17408
    s_nop 0
    global_load_lds_dwordx4 v[14:15], off
    v_lshl_add_u64 v[14:15], v[16:17], 0, v[14:15]
    v_fmac_f32 v37, v43, v43
    v_and_b32 v40, s72, v174
    v_lshlrev_b32 v41, 16, v174
    v_mfma_f32_32x32x16_bf16 v[112:127], v[140:143], v[176:179], v[112:127]
    s_add_u32 m0, s61, 18432
    s_nop 0
    global_load_lds_dwordx4 v[14:15], off
    v_lshl_add_u64 v[14:15], v[16:17], 0, v[14:15]
    v_add_f32 v36, v36, v40
    v_fmac_f32 v37, v40, v40
    s_waitcnt lgkmcnt(0)
    v_mfma_f32_16x16x32_bf16 v[160:163], v[168:171], v[152:155], v[160:163]
    ds_read_b64_tr_b16 v[136:137], v30 offset:0
    ds_read_b64_tr_b16 v[138:139], v30 offset:1024
    ds_read_b128 v[128:131], v26 offset:0
    ds_read_b64_tr_b16 v[140:141], v30 offset:4096
    ds_read_b64_tr_b16 v[142:143], v30 offset:5120
    ds_read_b128 v[132:135], v26 offset:4096
    v_add_f32 v36, v36, v41
    v_fmac_f32 v37, v41, v41
    v_and_b32 v42, s72, v175
    v_mfma_f32_32x32x16_bf16 v[64:79], v[152:155], v[144:147], v[64:79]
    v_lshlrev_b32 v43, 16, v175
    v_add_f32 v36, v36, v42
    v_fmac_f32 v37, v42, v42
    v_mfma_f32_32x32x16_bf16 v[80:95], v[152:155], v[148:151], v[80:95]
    v_add_f32 v36, v36, v43
    v_fmac_f32 v37, v43, v43
    v_mfma_f32_16x16x32_bf16 v[164:167], v[168:171], v[156:159], v[164:167]
    v_and_b32 v40, s72, v176
    v_lshlrev_b32 v41, 16, v176
    v_add_f32 v38, v38, v40
    v_mfma_f32_32x32x16_bf16 v[96:111], v[156:159], v[144:147], v[96:111]
    s_add_u32 m0, s60, 33792
    s_nop 0
    buffer_load_dwordx4 v9, s[28:31], s59 offen lds
    s_add_u32 s59, s59, 128
    v_fmac_f32 v39, v40, v40
    v_add_f32 v38, v38, v41
    v_fmac_f32 v39, v41, v41
    v_mfma_f32_32x32x16_bf16 v[112:127], v[156:159], v[148:151], v[112:127]
    s_add_u32 m0, s61, 19456
    s_nop 0
    global_load_lds_dwordx4 v[14:15], off
    v_lshl_add_u64 v[14:15], v[18:19], 0, v[14:15]
    v_and_b32 v42, s72, v177
    v_lshlrev_b32 v43, 16, v177
    s_waitcnt lgkmcnt(0)
    v_mfma_f32_32x32x16_bf16 v[64:79], v[136:139], v[128:131], v[64:79]
    ds_read_b64_tr_b16 v[152:153], v31 offset:0
    ds_read_b64_tr_b16 v[154:155], v31 offset:1024
    ds_read_b128 v[144:147], v27 offset:0
    ds_read_b64_tr_b16 v[156:157], v31 offset:4096
    ds_read_b64_tr_b16 v[158:159], v31 offset:5120
    ds_read_b128 v[148:151], v27 offset:4096
    v_add_f32 v38, v38, v42
    v_fmac_f32 v39, v42, v42
    v_add_f32 v38, v38, v43
    v_fmac_f32 v39, v43, v43
    v_mfma_f32_32x32x16_bf16 v[80:95], v[136:139], v[132:135], v[80:95]
    v_and_b32 v40, s72, v178
    v_lshlrev_b32 v41, 16, v178
    v_add_f32 v38, v38, v40
    v_fmac_f32 v39, v40, v40
    v_mfma_f32_32x32x16_bf16 v[96:111], v[140:143], v[128:131], v[96:111]
    v_add_f32 v38, v38, v41
    v_fmac_f32 v39, v41, v41
    v_and_b32 v42, s72, v179
    v_lshlrev_b32 v43, 16, v179
    v_mfma_f32_32x32x16_bf16 v[112:127], v[140:143], v[132:135], v[112:127]
    v_add_f32 v38, v38, v42
    v_fmac_f32 v39, v42, v42
    v_add_f32 v38, v38, v43
    v_fmac_f32 v39, v43, v43
    s_waitcnt vmcnt(6) lgkmcnt(0)
    s_barrier
    v_mfma_f32_32x32x16_bf16 v[64:79], v[152:155], v[144:147], v[64:79]
    ds_read_b64_tr_b16 v[136:137], v28 offset:8192
    ds_read_b64_tr_b16 v[138:139], v28 offset:9216
    ds_read_b128 v[172:175], v24 offset:16384
    ds_read_b64_tr_b16 v[140:141], v28 offset:12288
    ds_read_b64_tr_b16 v[142:143], v28 offset:13312
    ds_read_b128 v[176:179], v24 offset:20480
    v_mfma_f32_32x32x16_bf16 v[80:95], v[152:155], v[148:151], v[80:95]
    v_mfma_f32_32x32x16_bf16 v[96:111], v[156:159], v[144:147], v[96:111]
    s_add_u32 m0, s61, 0
    s_nop 0
    global_load_lds_dwordx4 v[14:15], off
    v_lshl_add_u64 v[14:15], v[16:17], 0, v[14:15]
    v_mfma_f32_32x32x16_bf16 v[112:127], v[156:159], v[148:151], v[112:127]
    s_add_u32 m0, s60, 0
    s_nop 0
    buffer_load_dwordx4 v8, s[28:31], s59 offen lds
    s_waitcnt lgkmcnt(0)
    v_mfma_f32_16x16x32_bf16 v[160:163], v[168:171], v[136:139], v[160:163]
    ds_read_b64_tr_b16 v[152:153], v29 offset:8192
    ds_read_b64_tr_b16 v[154:155], v29 offset:9216
    ds_read_b128 v[144:147], v25 offset:16384
    ds_read_b64_tr_b16 v[156:157], v29 offset:12288
    ds_read_b64_tr_b16 v[158:159], v29 offset:13312
    ds_read_b128 v[148:151], v25 offset:20480
    v_and_b32 v40, s72, v172
    v_lshlrev_b32 v41, 16, v172
    v_add_f32 v36, v36, v40
    v_mfma_f32_32x32x16_bf16 v[64:79], v[136:139], v[172:175], v[64:79]
    v_fmac_f32 v37, v40, v40
    v_add_f32 v36, v36, v41
    v_fmac_f32 v37, v41, v41
    v_mfma_f32_32x32x16_bf16 v[80:95], v[136:139], v[176:179], v[80:95]
    v_and_b32 v42, s72, v173
    v_lshlrev_b32 v43, 16, v173
    v_mfma_f32_16x16x32_bf16 v[164:167], v[168:171], v[140:143], v[164:167]
    v_add_f32 v36, v36, v42
    v_fmac_f32 v37, v42, v42
    v_add_f32 v36, v36, v43
    v_mfma_f32_32x32x16_bf16 v[96:111], v[140:143], v[172:175], v[96:111]
    s_add_u32 m0, s61, 1024
    s_nop 0
    global_load_lds_dwordx4 v[14:15], off
    v_lshl_add_u64 v[14:15], v[16:17], 0, v[14:15]
    v_fmac_f32 v37, v43, v43
    v_and_b32 v40, s72, v174
    v_lshlrev_b32 v41, 16, v174
    v_mfma_f32_32x32x16_bf16 v[112:127], v[140:143], v[176:179], v[112:127]
    s_add_u32 m0, s61, 2048
    s_nop 0
    global_load_lds_dwordx4 v[14:15], off
    v_lshl_add_u64 v[14:15], v[16:17], 0, v[14:15]
    v_add_f32 v36, v36, v40
    v_fmac_f32 v37, v40, v40
    s_waitcnt lgkmcnt(0)
    v_mfma_f32_16x16x32_bf16 v[160:163], v[168:171], v[152:155], v[160:163]
    ds_read_b64_tr_b16 v[136:137], v30 offset:8192
    ds_read_b64_tr_b16 v[138:139], v30 offset:9216
    ds_read_b128 v[128:131], v26 offset:16384
    ds_read_b64_tr_b16 v[140:141], v30 offset:12288
    ds_read_b64_tr_b16 v[142:143], v30 offset:13312
    ds_read_b128 v[132:135], v26 offset:20480
    v_add_f32 v36, v36, v41
    v_fmac_f32 v37, v41, v41
    v_and_b32 v42, s72, v175
    v_mfma_f32_32x32x16_bf16 v[64:79], v[152:155], v[144:147], v[64:79]
    v_lshlrev_b32 v43, 16, v175
    v_add_f32 v36, v36, v42
    v_fmac_f32 v37, v42, v42
    v_mfma_f32_32x32x16_bf16 v[80:95], v[152:155], v[148:151], v[80:95]
    v_add_f32 v36, v36, v43
    v_fmac_f32 v37, v43, v43
    v_mfma_f32_16x16x32_bf16 v[164:167], v[168:171], v[156:159], v[164:167]
    v_and_b32 v40, s72, v176
    v_lshlrev_b32 v41, 16, v176
    v_add_f32 v38, v38, v40
    v_mfma_f32_32x32x16_bf16 v[96:111], v[156:159], v[144:147], v[96:111]
    s_add_u32 m0, s60, 1024
    s_nop 0
    buffer_load_dwordx4 v9, s[28:31], s59 offen lds
    s_add_u32 s59, s59, 128
    v_fmac_f32 v39, v40, v40
    v_add_f32 v38, v38, v41
    v_fmac_f32 v39, v41, v41
    v_mfma_f32_32x32x16_bf16 v[112:127], v[156:159], v[148:151], v[112:127]
    s_add_u32 m0, s61, 3072
    s_nop 0
    global_load_lds_dwordx4 v[14:15], off
    v_lshl_add_u64 v[14:15], v[18:19], 0, v[14:15]
    v_and_b32 v42, s72, v177
    v_lshlrev_b32 v43, 16, v177
    s_waitcnt lgkmcnt(0)
    v_mfma_f32_32x32x16_bf16 v[64:79], v[136:139], v[128:131], v[64:79]
    ds_read_b64_tr_b16 v[152:153], v31 offset:8192
    ds_read_b64_tr_b16 v[154:155], v31 offset:9216
    ds_read_b128 v[144:147], v27 offset:16384
    ds_read_b64_tr_b16 v[156:157], v31 offset:12288
    ds_read_b64_tr_b16 v[158:159], v31 offset:13312
    ds_read_b128 v[148:151], v27 offset:20480
    v_add_f32 v38, v38, v42
    v_fmac_f32 v39, v42, v42
    v_add_f32 v38, v38, v43
    v_fmac_f32 v39, v43, v43
    v_mfma_f32_32x32x16_bf16 v[80:95], v[136:139], v[132:135], v[80:95]
    v_and_b32 v40, s72, v178
    v_lshlrev_b32 v41, 16, v178
    v_add_f32 v38, v38, v40
    v_fmac_f32 v39, v40, v40
    v_mfma_f32_32x32x16_bf16 v[96:111], v[140:143], v[128:131], v[96:111]
    v_add_f32 v38, v38, v41
    v_fmac_f32 v39, v41, v41
    v_and_b32 v42, s72, v179
    v_lshlrev_b32 v43, 16, v179
    v_mfma_f32_32x32x16_bf16 v[112:127], v[140:143], v[132:135], v[112:127]
    v_add_f32 v38, v38, v42
    v_fmac_f32 v39, v42, v42
    v_add_f32 v38, v38, v43
    v_fmac_f32 v39, v43, v43
    s_waitcnt vmcnt(6) lgkmcnt(0)
    s_barrier
    v_mfma_f32_32x32x16_bf16 v[64:79], v[152:155], v[144:147], v[64:79]
    ds_read_b64_tr_b16 v[136:137], v28 offset:16384
    ds_read_b64_tr_b16 v[138:139], v28 offset:17408
    ds_read_b128 v[172:175], v24 offset:32768
    ds_read_b64_tr_b16 v[140:141], v28 offset:20480
    ds_read_b64_tr_b16 v[142:143], v28 offset:21504
    ds_read_b128 v[176:179], v24 offset:36864
    v_mfma_f32_32x32x16_bf16 v[80:95], v[152:155], v[148:151], v[80:95]
    v_mfma_f32_32x32x16_bf16 v[96:111], v[156:159], v[144:147], v[96:111]
    v_mfma_f32_32x32x16_bf16 v[112:127], v[156:159], v[148:151], v[112:127]
    s_waitcnt lgkmcnt(0)
    v_mfma_f32_16x16x32_bf16 v[160:163], v[168:171], v[136:139], v[160:163]
    ds_read_b64_tr_b16 v[152:153], v29 offset:16384
    ds_read_b64_tr_b16 v[154:155], v29 offset:17408
    ds_read_b128 v[144:147], v25 offset:32768
    ds_read_b64_tr_b16 v[156:157], v29 offset:20480
    ds_read_b64_tr_b16 v[158:159], v29 offset:21504
    ds_read_b128 v[148:151], v25 offset:36864
    v_and_b32 v40, s72, v172
    v_lshlrev_b32 v41, 16, v172
    v_add_f32 v36, v36, v40
    v_mfma_f32_32x32x16_bf16 v[64:79], v[136:139], v[172:175], v[64:79]
    v_fmac_f32 v37, v40, v40
    v_add_f32 v36, v36, v41
    v_fmac_f32 v37, v41, v41
    v_mfma_f32_32x32x16_bf16 v[80:95], v[136:139], v[176:179], v[80:95]
    v_and_b32 v42, s72, v173
    v_lshlrev_b32 v43, 16, v173
    v_mfma_f32_16x16x32_bf16 v[164:167], v[168:171], v[140:143], v[164:167]
    v_add_f32 v36, v36, v42
    v_fmac_f32 v37, v42, v42
    v_add_f32 v36, v36, v43
    v_mfma_f32_32x32x16_bf16 v[96:111], v[140:143], v[172:175], v[96:111]
    v_fmac_f32 v37, v43, v43
    v_and_b32 v40, s72, v174
    v_lshlrev_b32 v41, 16, v174
    v_mfma_f32_32x32x16_bf16 v[112:127], v[140:143], v[176:179], v[112:127]
    v_add_f32 v36, v36, v40
    v_fmac_f32 v37, v40, v40
    s_waitcnt lgkmcnt(0)
    v_mfma_f32_16x16x32_bf16 v[160:163], v[168:171], v[152:155], v[160:163]
    ds_read_b64_tr_b16 v[136:137], v30 offset:16384
    ds_read_b64_tr_b16 v[138:139], v30 offset:17408
    ds_read_b128 v[128:131], v26 offset:32768
    ds_read_b64_tr_b16 v[140:141], v30 offset:20480
    ds_read_b64_tr_b16 v[142:143], v30 offset:21504
    ds_read_b128 v[132:135], v26 offset:36864
    v_add_f32 v36, v36, v41
    v_fmac_f32 v37, v41, v41
    v_and_b32 v42, s72, v175
    v_mfma_f32_32x32x16_bf16 v[64:79], v[152:155], v[144:147], v[64:79]
    v_lshlrev_b32 v43, 16, v175
    v_add_f32 v36, v36, v42
    v_fmac_f32 v37, v42, v42
    v_mfma_f32_32x32x16_bf16 v[80:95], v[152:155], v[148:151], v[80:95]
    v_add_f32 v36, v36, v43
    v_fmac_f32 v37, v43, v43
    v_mfma_f32_16x16x32_bf16 v[164:167], v[168:171], v[156:159], v[164:167]
    v_and_b32 v40, s72, v176
    v_lshlrev_b32 v41, 16, v176
    v_add_f32 v38, v38, v40
    v_mfma_f32_32x32x16_bf16 v[96:111], v[156:159], v[144:147], v[96:111]
    v_fmac_f32 v39, v40, v40
    v_add_f32 v38, v38, v41
    v_fmac_f32 v39, v41, v41
    v_mfma_f32_32x32x16_bf16 v[112:127], v[156:159], v[148:151], v[112:127]
    v_and_b32 v42, s72, v177
    v_lshlrev_b32 v43, 16, v177
    s_waitcnt lgkmcnt(0)
    v_mfma_f32_32x32x16_bf16 v[64:79], v[136:139], v[128:131], v[64:79]
    ds_read_b64_tr_b16 v[152:153], v31 offset:16384
    ds_read_b64_tr_b16 v[154:155], v31 offset:17408
    ds_read_b128 v[144:147], v27 offset:32768
    ds_read_b64_tr_b16 v[156:157], v31 offset:20480
    ds_read_b64_tr_b16 v[158:159], v31 offset:21504
    ds_read_b128 v[148:151], v27 offset:36864
    v_add_f32 v38, v38, v42
    v_fmac_f32 v39, v42, v42
    v_add_f32 v38, v38, v43
    v_fmac_f32 v39, v43, v43
    v_mfma_f32_32x32x16_bf16 v[80:95], v[136:139], v[132:135], v[80:95]
    v_and_b32 v40, s72, v178
    v_lshlrev_b32 v41, 16, v178
    v_add_f32 v38, v38, v40
    v_fmac_f32 v39, v40, v40
    v_mfma_f32_32x32x16_bf16 v[96:111], v[140:143], v[128:131], v[96:111]
    v_add_f32 v38, v38, v41
    v_fmac_f32 v39, v41, v41
    v_and_b32 v42, s72, v179
    v_lshlrev_b32 v43, 16, v179
    v_mfma_f32_32x32x16_bf16 v[112:127], v[140:143], v[132:135], v[112:127]
    v_add_f32 v38, v38, v42
    v_fmac_f32 v39, v42, v42
    v_add_f32 v38, v38, v43
    v_fmac_f32 v39, v43, v43
    s_waitcnt vmcnt(0) lgkmcnt(0)
    s_barrier
    v_mfma_f32_32x32x16_bf16 v[64:79], v[152:155], v[144:147], v[64:79]
    ds_read_b64_tr_b16 v[136:137], v28 offset:0
    ds_read_b64_tr_b16 v[138:139], v28 offset:1024
    ds_read_b128 v[172:175], v24 offset:0
    ds_read_b64_tr_b16 v[140:141], v28 offset:4096
    ds_read_b64_tr_b16 v[142:143], v28 offset:5120
    ds_read_b128 v[176:179], v24 offset:4096
    v_mfma_f32_32x32x16_bf16 v[80:95], v[152:155], v[148:151], v[80:95]
    v_mfma_f32_32x32x16_bf16 v[96:111], v[156:159], v[144:147], v[96:111]
    s_getpc_b64 s[34:35]
    k1_pc:
    s_lshl_b32 s27, s3, 12
    v_lshlrev_b32 v62, 7, v6
    v_add_u32 v62, s27, v62
    v_min_u32 v62, k2_last-k1_pc, v62
    global_load_dword v63, v62, s[34:35]
    v_mfma_f32_32x32x16_bf16 v[112:127], v[156:159], v[148:151], v[112:127]
    buffer_store_dwordx4 v[248:251], v49, s[40:43], s26 offen sc1
    s_waitcnt lgkmcnt(0)
    v_mfma_f32_16x16x32_bf16 v[160:163], v[168:171], v[136:139], v[160:163]
    ds_read_b64_tr_b16 v[152:153], v29 offset:0
    ds_read_b64_tr_b16 v[154:155], v29 offset:1024
    ds_read_b128 v[144:147], v25 offset:0
    ds_read_b64_tr_b16 v[156:157], v29 offset:4096
    ds_read_b64_tr_b16 v[158:159], v29 offset:5120
    ds_read_b128 v[148:151], v25 offset:4096
    v_and_b32 v40, s72, v172
    v_lshlrev_b32 v41, 16, v172
    v_add_f32 v36, v36, v40
    v_fmac_f32 v37, v40, v40
    v_mfma_f32_32x32x16_bf16 v[64:79], v[136:139], v[172:175], v[64:79]
    v_add_f32 v36, v36, v41
    v_fmac_f32 v37, v41, v41
    v_and_b32 v42, s72, v173
    v_lshlrev_b32 v43, 16, v173
    v_mfma_f32_32x32x16_bf16 v[80:95], v[136:139], v[176:179], v[80:95]
    v_add_f32 v36, v36, v42
    v_fmac_f32 v37, v42, v42
    v_add_f32 v36, v36, v43
    v_fmac_f32 v37, v43, v43
    v_mfma_f32_16x16x32_bf16 v[164:167], v[168:171], v[140:143], v[164:167]
    v_and_b32 v40, s72, v174
    v_lshlrev_b32 v41, 16, v174
    v_add_f32 v36, v36, v40
    v_fmac_f32 v37, v40, v40
    v_mfma_f32_32x32x16_bf16 v[96:111], v[140:143], v[172:175], v[96:111]
    buffer_store_dwordx4 v[228:231], v49, s[40:43], s67 offen sc1
    v_add_f32 v36, v36, v41
    v_fmac_f32 v37, v41, v41
    v_and_b32 v42, s72, v175
    v_lshlrev_b32 v43, 16, v175
    v_mfma_f32_32x32x16_bf16 v[112:127], v[140:143], v[176:179], v[112:127]
    v_add_f32 v36, v36, v42
    v_fmac_f32 v37, v42, v42
    v_add_f32 v36, v36, v43
    v_fmac_f32 v37, v43, v43
    s_waitcnt lgkmcnt(0)
    v_mfma_f32_16x16x32_bf16 v[160:163], v[168:171], v[152:155], v[160:163]
    ds_read_b64_tr_b16 v[136:137], v30 offset:0
    ds_read_b64_tr_b16 v[138:139], v30 offset:1024
    ds_read_b128 v[128:131], v26 offset:0
    ds_read_b64_tr_b16 v[140:141], v30 offset:4096
    ds_read_b64_tr_b16 v[142:143], v30 offset:5120
    ds_read_b128 v[132:135], v26 offset:4096
    v_and_b32 v40, s72, v176
    v_lshlrev_b32 v41, 16, v176
    v_add_f32 v38, v38, v40
    v_fmac_f32 v39, v40, v40
    v_mfma_f32_16x16x32_bf16 v[164:167], v[168:171], v[156:159], v[164:167]
    v_add_f32 v38, v38, v41
    v_fmac_f32 v39, v41, v41
    v_and_b32 v42, s72, v177
    v_lshlrev_b32 v43, 16, v177
    v_mfma_f32_32x32x16_bf16 v[64:79], v[152:155], v[144:147], v[64:79]
    v_add_f32 v38, v38, v42
    v_fmac_f32 v39, v42, v42
    v_add_f32 v38, v38, v43
    v_fmac_f32 v39, v43, v43
    v_mfma_f32_32x32x16_bf16 v[80:95], v[152:155], v[148:151], v[80:95]
    v_and_b32 v40, s72, v178
    v_lshlrev_b32 v41, 16, v178
    v_add_f32 v38, v38, v40
    v_fmac_f32 v39, v40, v40
    v_mfma_f32_32x32x16_bf16 v[96:111], v[156:159], v[144:147], v[96:111]
    v_add_f32 v38, v38, v41
    v_fmac_f32 v39, v41, v41
    v_and_b32 v42, s72, v179
    v_lshlrev_b32 v43, 16, v179
    v_mfma_f32_32x32x16_bf16 v[112:127], v[156:159], v[148:151], v[112:127]
    v_add_f32 v38, v38, v42
    v_fmac_f32 v39, v42, v42
    v_add_f32 v38, v38, v43
    v_fmac_f32 v39, v43, v43
    s_mov_b32 exec_hi, 0
    ds_write_b32 v47, v160
    ds_write_b32 v47, v164 offset:256
    s_mov_b32 exec_hi, -1
    ds_write_b64 v45, v[36:37]
    ds_write_b64 v45, v[38:39] offset:2048
    s_waitcnt lgkmcnt(0)
    s_barrier
    v_mfma_f32_32x32x16_bf16 v[64:79], v[136:139], v[128:131], v[64:79]
    ds_read_b128 v[196:199], v44 offset:0
    ds_read_b128 v[200:203], v44 offset:16
    ds_read_b128 v[204:207], v44 offset:32
    ds_read_b128 v[208:211], v44 offset:48
    ds_read_b128 v[212:215], v44 offset:2048
    ds_read_b128 v[216:219], v44 offset:2064
    ds_read_b128 v[220:223], v44 offset:2080
    ds_read_b128 v[224:227], v44 offset:2096
    ds_read2_b32 v[50:51], v46 offset0:0 offset1:32
    ds_read2_b32 v[52:53], v46 offset0:64 offset1:96
    ds_read_b64_tr_b16 v[152:153], v31 offset:0
    ds_read_b64_tr_b16 v[154:155], v31 offset:1024
    ds_read_b128 v[144:147], v27 offset:0
    ds_read_b64_tr_b16 v[156:157], v31 offset:4096
    ds_read_b64_tr_b16 v[158:159], v31 offset:5120
    ds_read_b128 v[148:151], v27 offset:4096
    v_mfma_f32_32x32x16_bf16 v[80:95], v[136:139], v[132:135], v[80:95]
    v_mfma_f32_32x32x16_bf16 v[96:111], v[140:143], v[128:131], v[96:111]
    v_mfma_f32_32x32x16_bf16 v[112:127], v[140:143], v[132:135], v[112:127]
    s_waitcnt lgkmcnt(0)
    v_mfma_f32_32x32x16_bf16 v[64:79], v[152:155], v[144:147], v[64:79]
    v_add_f32 v196, v196, v204
    v_add_f32 v197, v197, v205
    v_add_f32 v198, v198, v206
    v_add_f32 v199, v199, v207
    v_add_f32 v200, v200, v208
    v_add_f32 v201, v201, v209
    v_add_f32 v202, v202, v210
    v_add_f32 v203, v203, v211
    v_add_f32 v212, v212, v220
    v_add_f32 v213, v213, v221
    v_add_f32 v214, v214, v222
    v_add_f32 v215, v215, v223
    v_add_f32 v216, v216, v224
    v_add_f32 v217, v217, v225
    v_add_f32 v218, v218, v226
    v_add_f32 v219, v219, v227
    v_add_f32 v196, v196, v200
    v_add_f32 v197, v197, v201
    v_add_f32 v198, v198, v202
    v_add_f32 v199, v199, v203
    v_mfma_f32_32x32x16_bf16 v[80:95], v[152:155], v[148:151], v[80:95]
    v_add_f32 v212, v212, v216
    v_add_f32 v213, v213, v217
    v_add_f32 v214, v214, v218
    v_add_f32 v215, v215, v219
    v_add_f32 v196, v196, v198
    v_add_f32 v197, v197, v199
    v_add_f32 v212, v212, v214
    v_add_f32 v213, v213, v215
    v_mul_f32 v196, s74, v196
    v_mul_f32 v212, s74, v212
    v_mul_f32 v197, s74, v197
    v_mul_f32 v213, s74, v213
    v_fma_f32 v197, -v196, v196, v197
    v_fma_f32 v213, -v212, v212, v213
    v_max_f32 v197, 0, v197
    v_max_f32 v213, 0, v213
    v_cvt_pk_bf16_f32 v180, -v196, -v196
    v_cvt_pk_bf16_f32 v184, -v212, -v212
    v_cvt_pk_bf16_f32 v197, v197, v197
    v_mfma_f32_32x32x16_bf16 v[96:111], v[156:159], v[144:147], v[96:111]
    v_cvt_pk_bf16_f32 v213, v213, v213
    v_and_b32 v197, s72, v197
    v_and_b32 v213, s72, v213
    v_add_f32 v197, 0x3727c5ac, v197
    v_add_f32 v213, 0x3727c5ac, v213
    v_cvt_pk_bf16_f32 v197, v197, v197
    v_cvt_pk_bf16_f32 v213, v213, v213
    v_and_b32 v197, s72, v197
    v_and_b32 v213, s72, v213
    v_sqrt_f32 v197, v197
    v_sqrt_f32 v213, v213
    v_mov_b32 v181, v180
    v_mov_b32 v185, v184
    v_cvt_pk_bf16_f32 v197, v197, v197
    v_cvt_pk_bf16_f32 v213, v213, v213
    v_and_b32 v54, s72, v197
    v_and_b32 v55, s72, v213
    v_rcp_f32 v56, v54
    v_rcp_f32 v57, v55
    v_mov_b32 v182, v180
    v_mfma_f32_32x32x16_bf16 v[112:127], v[156:159], v[148:151], v[112:127]
    v_mov_b32 v186, v184
    v_mov_b32 v183, v180
    v_mov_b32 v187, v184
    v_add_f32 v50, v50, v51
    v_cndmask_b32 v50, 0, v50, vcc
    v_and_b32 v58, s72, v50
    v_sub_f32 v59, v50, v58
    v_and_b32 v60, s72, v59
    v_sub_f32 v61, v59, v60
    v_perm_b32 v188, v60, v58, s73
    v_lshrrev_b32 v189, 16, v61
    v_add_f32 v52, v52, v53
    v_cndmask_b32 v52, 0, v52, vcc
    v_and_b32 v58, s72, v52
    v_sub_f32 v59, v52, v58
    v_and_b32 v60, s72, v59
    v_sub_f32 v61, v59, v60
    v_perm_b32 v192, v60, v58, s73
    v_lshrrev_b32 v193, 16, v61
    s_nop 1
    v_mfma_f32_32x32x16_bf16 v[64:79], v[188:191], v[180:183], v[64:79]
    v_mfma_f32_32x32x16_bf16 v[96:111], v[192:195], v[180:183], v[96:111]
    v_mfma_f32_32x32x16_bf16 v[80:95], v[188:191], v[184:187], v[80:95]
    v_mfma_f32_32x32x16_bf16 v[112:127], v[192:195], v[184:187], v[112:127]
    s_cmp_ge_u32 s7, 14
    s_cbranch_scc1 k1_qkv
    v_mul_f32 v58, 0xbfb8aa3b, v56
    v_mul_f32 v59, 0xbfb8aa3b, v57
    s_mul_i32 s76, s75, 114688
    s_lshl_b32 s62, s7, 2
    s_add_u32 s62, s62, s47
    s_lshl_b32 s62, s62, 11
    s_add_u32 s76, s76, s62
    s_add_u32 s76, s76, 7077888
    s_add_u32 s77, s76, 114688
    s_cmp_eq_u32 s44, 1
    s_nop 3
    v_pk_mul_f32 v[64:65], v[64:65], v[58:59] op_sel:[0,0] op_sel_hi:[1,0]
    v_pk_mul_f32 v[66:67], v[66:67], v[58:59] op_sel:[0,0] op_sel_hi:[1,0]
    v_pk_mul_f32 v[68:69], v[68:69], v[58:59] op_sel:[0,0] op_sel_hi:[1,0]
    v_pk_mul_f32 v[70:71], v[70:71], v[58:59] op_sel:[0,0] op_sel_hi:[1,0]
    v_exp_f32 v64, v64
    v_exp_f32 v65, v65
    v_exp_f32 v66, v66
    v_exp_f32 v67, v67
    v_exp_f32 v68, v68
    v_exp_f32 v69, v69
    v_exp_f32 v70, v70
    v_exp_f32 v71, v71
    v_pk_fma_f32 v[64:65], v[64:65], v[54:55], v[54:55] op_sel:[0,0,0] op_sel_hi:[1,0,0]
    v_pk_fma_f32 v[66:67], v[66:67], v[54:55], v[54:55] op_sel:[0,0,0] op_sel_hi:[1,0,0]
    v_pk_fma_f32 v[68:69], v[68:69], v[54:55], v[54:55] op_sel:[0,0,0] op_sel_hi:[1,0,0]
    v_pk_fma_f32 v[70:71], v[70:71], v[54:55], v[54:55] op_sel:[0,0,0] op_sel_hi:[1,0,0]
    v_rcp_f32 v64, v64
    v_rcp_f32 v65, v65
    v_rcp_f32 v66, v66
    v_rcp_f32 v67, v67
    v_rcp_f32 v68, v68
    v_rcp_f32 v69, v69
    v_rcp_f32 v70, v70
    v_rcp_f32 v71, v71
    v_pk_mul_f32 v[96:97], v[96:97], v[64:65]
    v_pk_mul_f32 v[98:99], v[98:99], v[66:67]
    v_pk_mul_f32 v[100:101], v[100:101], v[68:69]
    v_pk_mul_f32 v[102:103], v[102:103], v[70:71]
    v_cvt_pk_bf16_f32 v128, v96, v97
    v_cvt_pk_bf16_f32 v129, v98, v99
    v_cvt_pk_bf16_f32 v130, v100, v101
    v_cvt_pk_bf16_f32 v131, v102, v103
    buffer_store_dwordx4 v[128:131], v49, s[40:43], s76 offen offset:0 sc1
    v_pk_mul_f32 v[72:73], v[72:73], v[58:59] op_sel:[0,0] op_sel_hi:[1,0]
    v_pk_mul_f32 v[74:75], v[74:75], v[58:59] op_sel:[0,0] op_sel_hi:[1,0]
    v_pk_mul_f32 v[76:77], v[76:77], v[58:59] op_sel:[0,0] op_sel_hi:[1,0]
    v_pk_mul_f32 v[78:79], v[78:79], v[58:59] op_sel:[0,0] op_sel_hi:[1,0]
    v_exp_f32 v72, v72
    v_exp_f32 v73, v73
    v_exp_f32 v74, v74
    v_exp_f32 v75, v75
    v_exp_f32 v76, v76
    v_exp_f32 v77, v77
    v_exp_f32 v78, v78
    v_exp_f32 v79, v79
    v_pk_fma_f32 v[72:73], v[72:73], v[54:55], v[54:55] op_sel:[0,0,0] op_sel_hi:[1,0,0]
    v_pk_fma_f32 v[74:75], v[74:75], v[54:55], v[54:55] op_sel:[0,0,0] op_sel_hi:[1,0,0]
    v_pk_fma_f32 v[76:77], v[76:77], v[54:55], v[54:55] op_sel:[0,0,0] op_sel_hi:[1,0,0]
    v_pk_fma_f32 v[78:79], v[78:79], v[54:55], v[54:55] op_sel:[0,0,0] op_sel_hi:[1,0,0]
    v_rcp_f32 v72, v72
    v_rcp_f32 v73, v73
    v_rcp_f32 v74, v74
    v_rcp_f32 v75, v75
    v_rcp_f32 v76, v76
    v_rcp_f32 v77, v77
    v_rcp_f32 v78, v78
    v_rcp_f32 v79, v79
    v_pk_mul_f32 v[104:105], v[104:105], v[72:73]
    v_pk_mul_f32 v[106:107], v[106:107], v[74:75]
    v_pk_mul_f32 v[108:109], v[108:109], v[76:77]
    v_pk_mul_f32 v[110:111], v[110:111], v[78:79]
    v_cvt_pk_bf16_f32 v132, v104, v105
    v_cvt_pk_bf16_f32 v133, v106, v107
    v_cvt_pk_bf16_f32 v134, v108, v109
    v_cvt_pk_bf16_f32 v135, v110, v111
    buffer_store_dwordx4 v[132:135], v49, s[40:43], s76 offen offset:1024 sc1
    v_pk_mul_f32 v[80:81], v[80:81], v[58:59] op_sel:[0,1] op_sel_hi:[1,1]
    v_pk_mul_f32 v[82:83], v[82:83], v[58:59] op_sel:[0,1] op_sel_hi:[1,1]
    v_pk_mul_f32 v[84:85], v[84:85], v[58:59] op_sel:[0,1] op_sel_hi:[1,1]
    v_pk_mul_f32 v[86:87], v[86:87], v[58:59] op_sel:[0,1] op_sel_hi:[1,1]
    v_exp_f32 v80, v80
    v_exp_f32 v81, v81
    v_exp_f32 v82, v82
    v_exp_f32 v83, v83
    v_exp_f32 v84, v84
    v_exp_f32 v85, v85
    v_exp_f32 v86, v86
    v_exp_f32 v87, v87
    v_pk_fma_f32 v[80:81], v[80:81], v[54:55], v[54:55] op_sel:[0,1,1] op_sel_hi:[1,1,1]
    v_pk_fma_f32 v[82:83], v[82:83], v[54:55], v[54:55] op_sel:[0,1,1] op_sel_hi:[1,1,1]
    v_pk_fma_f32 v[84:85], v[84:85], v[54:55], v[54:55] op_sel:[0,1,1] op_sel_hi:[1,1,1]
    v_pk_fma_f32 v[86:87], v[86:87], v[54:55], v[54:55] op_sel:[0,1,1] op_sel_hi:[1,1,1]
    v_rcp_f32 v80, v80
    v_rcp_f32 v81, v81
    v_rcp_f32 v82, v82
    v_rcp_f32 v83, v83
    v_rcp_f32 v84, v84
    v_rcp_f32 v85, v85
    v_rcp_f32 v86, v86
    v_rcp_f32 v87, v87
    v_pk_mul_f32 v[112:113], v[112:113], v[80:81]
    v_pk_mul_f32 v[114:115], v[114:115], v[82:83]
    v_pk_mul_f32 v[116:117], v[116:117], v[84:85]
    v_pk_mul_f32 v[118:119], v[118:119], v[86:87]
    v_cvt_pk_bf16_f32 v136, v112, v113
    v_cvt_pk_bf16_f32 v137, v114, v115
    v_cvt_pk_bf16_f32 v138, v116, v117
    v_cvt_pk_bf16_f32 v139, v118, v119
    buffer_store_dwordx4 v[136:139], v49, s[40:43], s77 offen offset:0 sc1
    v_pk_mul_f32 v[88:89], v[88:89], v[58:59] op_sel:[0,1] op_sel_hi:[1,1]
    v_pk_mul_f32 v[90:91], v[90:91], v[58:59] op_sel:[0,1] op_sel_hi:[1,1]
    v_pk_mul_f32 v[92:93], v[92:93], v[58:59] op_sel:[0,1] op_sel_hi:[1,1]
    v_pk_mul_f32 v[94:95], v[94:95], v[58:59] op_sel:[0,1] op_sel_hi:[1,1]
    v_exp_f32 v88, v88
    v_exp_f32 v89, v89
    v_exp_f32 v90, v90
    v_exp_f32 v91, v91
    v_exp_f32 v92, v92
    v_exp_f32 v93, v93
    v_exp_f32 v94, v94
    v_exp_f32 v95, v95
    v_pk_fma_f32 v[88:89], v[88:89], v[54:55], v[54:55] op_sel:[0,1,1] op_sel_hi:[1,1,1]
    v_pk_fma_f32 v[90:91], v[90:91], v[54:55], v[54:55] op_sel:[0,1,1] op_sel_hi:[1,1,1]
    v_pk_fma_f32 v[92:93], v[92:93], v[54:55], v[54:55] op_sel:[0,1,1] op_sel_hi:[1,1,1]
    v_pk_fma_f32 v[94:95], v[94:95], v[54:55], v[54:55] op_sel:[0,1,1] op_sel_hi:[1,1,1]
    v_rcp_f32 v88, v88
    v_rcp_f32 v89, v89
    v_rcp_f32 v90, v90
    v_rcp_f32 v91, v91
    v_rcp_f32 v92, v92
    v_rcp_f32 v93, v93
    v_rcp_f32 v94, v94
    v_rcp_f32 v95, v95
    v_pk_mul_f32 v[120:121], v[120:121], v[88:89]
    v_pk_mul_f32 v[122:123], v[122:123], v[90:91]
    v_pk_mul_f32 v[124:125], v[124:125], v[92:93]
    v_pk_mul_f32 v[126:127], v[126:127], v[94:95]
    v_cvt_pk_bf16_f32 v140, v120, v121
    v_cvt_pk_bf16_f32 v141, v122, v123
    v_cvt_pk_bf16_f32 v142, v124, v125
    v_cvt_pk_bf16_f32 v143, v126, v127
    buffer_store_dwordx4 v[140:143], v49, s[40:43], s77 offen offset:1024 sc1
    s_endpgm
k1_qkv:
    s_sub_u32 s76, s7, 14
    s_lshl_b32 s76, s76, 3
    s_add_u32 s76, s76, s47
    s_mov_b32 s77, 0x3e8b97f6
    s_cmp_ge_u32 s76, 10
    s_cselect_b32 s78, 1.0, s77
    s_cselect_b32 s71, -1, 0
    s_mov_b32 s70, 0
    s_cmp_eq_u32 s76, 10
    s_cselect_b32 s79, 0x3f803f80, 0
    s_cselect_b32 s80, 0x3f80, 0
    s_or_b32 s79, s79, 0x3f80
    v_mov_b32 v40, s79
    v_mov_b32 v41, s80
    v_mul_f32 v58, s77, v56
    v_mul_f32 v59, s77, v57
    v_mul_f32 v60, s78, v56
    v_mul_f32 v61, s78, v57
    s_mul_i32 s62, s46, 49152
    s_add_u32 s62, s62, 57344
    v_and_b32 v42, 15, v0
    s_lshl_b32 s69, s47, 2
    v_xor_b32 v42, s69, v42
    v_lshlrev_b32 v42, 4, v42
    v_lshl_add_u32 v42, v5, 3, v42
    v_lshl_add_u32 v42, v6, 9, v42
    v_add_u32 v42, s62, v42
    v_xor_b32 v33, 16, v42
    v_xor_b32 v34, 32, v42
    v_xor_b32 v35, 48, v42
    v_mov_b32 v32, v42
    v_pk_mul_f32 v[64:65], v[64:65], v[58:59] op_sel:[0,0] op_sel_hi:[1,0]
    v_pk_mul_f32 v[66:67], v[66:67], v[58:59] op_sel:[0,0] op_sel_hi:[1,0]
    v_pk_mul_f32 v[68:69], v[68:69], v[58:59] op_sel:[0,0] op_sel_hi:[1,0]
    v_pk_mul_f32 v[70:71], v[70:71], v[58:59] op_sel:[0,0] op_sel_hi:[1,0]
    v_pk_mul_f32 v[72:73], v[72:73], v[58:59] op_sel:[0,0] op_sel_hi:[1,0]
    v_pk_mul_f32 v[74:75], v[74:75], v[58:59] op_sel:[0,0] op_sel_hi:[1,0]
    v_pk_mul_f32 v[76:77], v[76:77], v[58:59] op_sel:[0,0] op_sel_hi:[1,0]
    v_pk_mul_f32 v[78:79], v[78:79], v[58:59] op_sel:[0,0] op_sel_hi:[1,0]
    v_cvt_pk_bf16_f32 v128, v64, v65
    v_cvt_pk_bf16_f32 v129, v66, v67
    v_cvt_pk_bf16_f32 v130, v68, v69
    v_cvt_pk_bf16_f32 v131, v70, v71
    v_cvt_pk_bf16_f32 v132, v72, v73
    v_cvt_pk_bf16_f32 v133, v74, v75
    v_cvt_pk_bf16_f32 v134, v76, v77
    v_cvt_pk_bf16_f32 v135, v78, v79
    ds_write_b64 v32, v[128:129] offset:0
    ds_write_b64 v33, v[130:131] offset:0
    ds_write_b64 v34, v[132:133] offset:0
    ds_write_b64 v35, v[134:135] offset:0
    v_pk_mul_f32 v[80:81], v[80:81], v[58:59] op_sel:[0,1] op_sel_hi:[1,1]
    v_pk_mul_f32 v[82:83], v[82:83], v[58:59] op_sel:[0,1] op_sel_hi:[1,1]
    v_pk_mul_f32 v[84:85], v[84:85], v[58:59] op_sel:[0,1] op_sel_hi:[1,1]
    v_pk_mul_f32 v[86:87], v[86:87], v[58:59] op_sel:[0,1] op_sel_hi:[1,1]
    v_pk_mul_f32 v[88:89], v[88:89], v[58:59] op_sel:[0,1] op_sel_hi:[1,1]
    v_pk_mul_f32 v[90:91], v[90:91], v[58:59] op_sel:[0,1] op_sel_hi:[1,1]
    v_pk_mul_f32 v[92:93], v[92:93], v[58:59] op_sel:[0,1] op_sel_hi:[1,1]
    v_pk_mul_f32 v[94:95], v[94:95], v[58:59] op_sel:[0,1] op_sel_hi:[1,1]
    v_cvt_pk_bf16_f32 v136, v80, v81
    v_cvt_pk_bf16_f32 v137, v82, v83
    v_cvt_pk_bf16_f32 v138, v84, v85
    v_cvt_pk_bf16_f32 v139, v86, v87
    v_cvt_pk_bf16_f32 v140, v88, v89
    v_cvt_pk_bf16_f32 v141, v90, v91
    v_cvt_pk_bf16_f32 v142, v92, v93
    v_cvt_pk_bf16_f32 v143, v94, v95
    ds_write_b64 v32, v[136:137] offset:24576
    ds_write_b64 v33, v[138:139] offset:24576
    ds_write_b64 v34, v[140:141] offset:24576
    ds_write_b64 v35, v[142:143] offset:24576
    v_pk_mul_f32 v[96:97], v[96:97], v[60:61] op_sel:[0,0] op_sel_hi:[1,0]
    v_pk_mul_f32 v[98:99], v[98:99], v[60:61] op_sel:[0,0] op_sel_hi:[1,0]
    v_pk_mul_f32 v[100:101], v[100:101], v[60:61] op_sel:[0,0] op_sel_hi:[1,0]
    v_pk_mul_f32 v[102:103], v[102:103], v[60:61] op_sel:[0,0] op_sel_hi:[1,0]
    v_pk_mul_f32 v[104:105], v[104:105], v[60:61] op_sel:[0,0] op_sel_hi:[1,0]
    v_pk_mul_f32 v[106:107], v[106:107], v[60:61] op_sel:[0,0] op_sel_hi:[1,0]
    v_pk_mul_f32 v[108:109], v[108:109], v[60:61] op_sel:[0,0] op_sel_hi:[1,0]
    v_pk_mul_f32 v[110:111], v[110:111], v[60:61] op_sel:[0,0] op_sel_hi:[1,0]
    v_cvt_pk_bf16_f32 v144, v96, v97
    v_cvt_pk_bf16_f32 v145, v98, v99
    v_cvt_pk_bf16_f32 v146, v100, v101
    v_cvt_pk_bf16_f32 v147, v102, v103
    v_cvt_pk_bf16_f32 v148, v104, v105
    v_cvt_pk_bf16_f32 v149, v106, v107
    v_cvt_pk_bf16_f32 v150, v108, v109
    v_cvt_pk_bf16_f32 v151, v110, v111
    v_cndmask_b32 v150, v150, v40, s[70:71]
    v_cndmask_b32 v151, v151, v41, s[70:71]
    ds_write_b64 v32, v[144:145] offset:256
    ds_write_b64 v33, v[146:147] offset:256
    ds_write_b64 v34, v[148:149] offset:256
    ds_write_b64 v35, v[150:151] offset:256
    v_pk_mul_f32 v[112:113], v[112:113], v[60:61] op_sel:[0,1] op_sel_hi:[1,1]
    v_pk_mul_f32 v[114:115], v[114:115], v[60:61] op_sel:[0,1] op_sel_hi:[1,1]
    v_pk_mul_f32 v[116:117], v[116:117], v[60:61] op_sel:[0,1] op_sel_hi:[1,1]
    v_pk_mul_f32 v[118:119], v[118:119], v[60:61] op_sel:[0,1] op_sel_hi:[1,1]
    v_pk_mul_f32 v[120:121], v[120:121], v[60:61] op_sel:[0,1] op_sel_hi:[1,1]
    v_pk_mul_f32 v[122:123], v[122:123], v[60:61] op_sel:[0,1] op_sel_hi:[1,1]
    v_pk_mul_f32 v[124:125], v[124:125], v[60:61] op_sel:[0,1] op_sel_hi:[1,1]
    v_pk_mul_f32 v[126:127], v[126:127], v[60:61] op_sel:[0,1] op_sel_hi:[1,1]
    v_cvt_pk_bf16_f32 v152, v112, v113
    v_cvt_pk_bf16_f32 v153, v114, v115
    v_cvt_pk_bf16_f32 v154, v116, v117
    v_cvt_pk_bf16_f32 v155, v118, v119
    v_cvt_pk_bf16_f32 v156, v120, v121
    v_cvt_pk_bf16_f32 v157, v122, v123
    v_cvt_pk_bf16_f32 v158, v124, v125
    v_cvt_pk_bf16_f32 v159, v126, v127
    v_cndmask_b32 v158, v158, v40, s[70:71]
    v_cndmask_b32 v159, v159, v41, s[70:71]
    ds_write_b64 v32, v[152:153] offset:24832
    ds_write_b64 v33, v[154:155] offset:24832
    ds_write_b64 v34, v[156:157] offset:24832
    ds_write_b64 v35, v[158:159] offset:24832
    s_mul_i32 s62, s47, 24576
    s_lshl_b32 s69, s46, 13
    s_add_u32 s62, s62, s69
    s_add_u32 s62, s62, 57344
    v_xor_b32 v43, v6, v5
    v_lshlrev_b32 v43, 4, v43
    v_lshl_add_u32 v43, v5, 9, v43
    v_add_u32 v43, s62, v43
    s_lshl_b32 s62, s6, 7
    s_add_u32 s62, s62, s49
    s_mul_i32 s62, s62, 896
    s_sub_u32 s69, s7, 14
    s_lshl_b32 s69, s69, 9
    s_add_u32 s81, s62, s69
    s_cmp_eq_u32 s7, 15
    s_cselect_b32 s69, 24, 32
    v_mul_u32_u24 v44, 896, v5
    v_lshl_add_u32 v44, v6, 4, v44
    v_cmp_gt_u32 vcc, s69, v6
    v_mov_b32 v45, 0x7fff0000
    s_waitcnt lgkmcnt(0)
    s_barrier
    v_cndmask_b32 v44, v45, v44, vcc
    s_cmp_eq_u32 s7, 14
    s_cbranch_scc1 k1_fin
    s_lshl_b32 s77, s6, 2
    s_add_u32 s77, s77, s45
    s_lshl_b32 s77, s77, 12
    s_add_u32 s77, s77, 2097152
    s_mul_i32 s62, s45, 24576
    s_add_u32 s62, s62, 57344
    s_cmp_eq_u32 s44, 1
    s_cbranch_scc1 k1_v
    v_and_b32 v52, 15, v0
    v_xor_b32 v52, v52, v5
    v_xor_b32 v52, 24, v52
    v_lshlrev_b32 v52, 4, v52
    v_lshl_add_u32 v52, v6, 9, v52
    v_add_u32 v52, s62, v52
    v_xor_b32 v53, 32, v52
    ds_read_b128 v[96:99], v52
    ds_read_b128 v[100:103], v53
    s_waitcnt lgkmcnt(0)
    buffer_store_dwordx4 v[96:99], v49, s[40:43], s77 offen
    buffer_store_dwordx4 v[100:103], v49, s[40:43], s77 offen offset:1024
    s_branch k1_fin
k1_v:
    v_lshl_add_u32 v52, v5, 2, v2
    v_and_b32 v53, 1, v1
    v_lshlrev_b32 v53, 1, v53
    v_bfe_u32 v55, v0, 1, 1
    v_add3_u32 v53, v53, v55, 28
    v_xor_b32 v53, v53, v52
    v_lshlrev_b32 v53, 4, v53
    v_lshl_add_u32 v53, v52, 9, v53
    v_and_b32 v55, 1, v0
    v_lshl_add_u32 v53, v55, 3, v53
    v_add_u32 v52, s62, v53
    v_xor_b32 v53, 128, v52
    ds_read_b64_tr_b16 v[96:97], v52
    ds_read_b64_tr_b16 v[98:99], v53 offset:4096
    ds_read_b64_tr_b16 v[100:101], v52 offset:8192
    ds_read_b64_tr_b16 v[102:103], v53 offset:12288
    s_waitcnt lgkmcnt(0)
    buffer_store_dwordx4 v[96:99], v49, s[40:43], s77 offen offset:2048
    buffer_store_dwordx4 v[100:103], v49, s[40:43], s77 offen offset:3072
k1_fin:
    v_xor_b32 v45, 0, v43
    ds_read_b128 v[64:67], v45 offset:0
    v_xor_b32 v45, 32, v43
    ds_read_b128 v[68:71], v45 offset:1024
    v_xor_b32 v45, 64, v43
    ds_read_b128 v[72:75], v45 offset:2048
    v_xor_b32 v45, 96, v43
    ds_read_b128 v[76:79], v45 offset:3072
    v_xor_b32 v45, 128, v43
    ds_read_b128 v[80:83], v45 offset:4096
    v_xor_b32 v45, 160, v43
    ds_read_b128 v[84:87], v45 offset:5120
    v_xor_b32 v45, 192, v43
    ds_read_b128 v[88:91], v45 offset:6144
    v_xor_b32 v45, 224, v43
    ds_read_b128 v[92:95], v45 offset:7168
    s_waitcnt lgkmcnt(7)
    buffer_store_dwordx4 v[64:67], v44, s[40:43], s81 offen
    s_add_u32 s81, s81, 1792
    s_waitcnt lgkmcnt(6)
    buffer_store_dwordx4 v[68:71], v44, s[40:43], s81 offen
    s_add_u32 s81, s81, 1792
    s_waitcnt lgkmcnt(5)
    buffer_store_dwordx4 v[72:75], v44, s[40:43], s81 offen
    s_add_u32 s81, s81, 1792
    s_waitcnt lgkmcnt(4)
    buffer_store_dwordx4 v[76:79], v44, s[40:43], s81 offen
    s_add_u32 s81, s81, 1792
    s_waitcnt lgkmcnt(3)
    buffer_store_dwordx4 v[80:83], v44, s[40:43], s81 offen
    s_add_u32 s81, s81, 1792
    s_waitcnt lgkmcnt(2)
    buffer_store_dwordx4 v[84:87], v44, s[40:43], s81 offen
    s_add_u32 s81, s81, 1792
    s_waitcnt lgkmcnt(1)
    buffer_store_dwordx4 v[88:91], v44, s[40:43], s81 offen
    s_add_u32 s81, s81, 1792
    s_waitcnt lgkmcnt(0)
    buffer_store_dwordx4 v[92:95], v44, s[40:43], s81 offen
    s_add_u32 s81, s81, 1792
k1_done:
    s_endpgm
.text
.globl k2_kernel
.p2align 8
.type k2_kernel,@function
k2_kernel:
    s_cmp_ge_u32 s2, 256
    s_cbranch_scc1 k2_done
    s_load_dwordx2 s[24:25], s[0:1], 88
    s_load_dwordx2 s[8:9], s[0:1], 0
    s_load_dwordx2 s[10:11], s[0:1], 72
    v_readfirstlane_b32 s3, v0
    v_and_b32 v0, 63, v0
    v_lshlrev_b32 v2, 4, v0
    v_lshrrev_b32 v5, 5, v0
    v_and_b32 v6, 31, v0
    s_lshr_b32 s3, s3, 6
    s_and_b32 s4, s2, 7
    s_lshl_b32 s4, s4, 2
    s_bfe_u32 s5, s2, 0x20003
    s_add_u32 s4, s4, s5
    s_lshr_b32 s5, s2, 5
    s_xor_b32 s6, s3, 3
    s_mov_b32 s72, 0xffff0000
    s_mov_b32 s73, 0x07060302
    s_mov_b32 s60, 0
    s_lshl_b32 s7, s4, 3
    s_add_u32 s7, s7, s5
    s_mul_i32 s12, s7, 7168
    v_lshrrev_b32 v1, 2, v6
    v_and_b32 v4, 3, v0
    v_mul_u32_u24 v3, 896, v1
    v_mad_u32_u24 v3, v4, 56, v3
    v_lshl_add_u32 v3, v5, 4, v3
    s_lshl_b32 s46, s3, 16
    s_add_u32 s46, s46, 2097152
    s_mov_b32 s47, 2097152
    s_xor_b32 s52, s6, 0
    s_mul_i32 s52, s52, 224
    s_add_u32 s52, s52, s12
    s_xor_b32 s53, s6, 1
    s_mul_i32 s53, s53, 224
    s_add_u32 s53, s53, s12
    s_xor_b32 s54, s6, 2
    s_mul_i32 s54, s54, 224
    s_add_u32 s54, s54, s12
    s_xor_b32 s55, s6, 3
    s_mul_i32 s55, s55, 224
    s_add_u32 s55, s55, s12
    s_waitcnt lgkmcnt(0)
    s_mov_b32 s40, s24
    s_and_b32 s41, s25, 0xffff
    s_mov_b32 s42, 0x1100000
    s_mov_b32 s43, 0x00020000
    buffer_load_dwordx4 v[208:211], v2, s[40:43], s47 offen
    buffer_load_dwordx4 v[212:215], v2, s[40:43], s47 offen offset:1024
    buffer_load_dwordx4 v[16:19], v3, s[40:43], s52 offen offset:0
    buffer_load_dwordx4 v[20:23], v3, s[40:43], s52 offen offset:32
    buffer_load_dwordx4 v[24:27], v3, s[40:43], s53 offen offset:0
    buffer_load_dwordx4 v[28:31], v3, s[40:43], s53 offen offset:32
    buffer_load_dwordx4 v[32:35], v3, s[40:43], s54 offen offset:0
    buffer_load_dwordx4 v[36:39], v3, s[40:43], s54 offen offset:32
    buffer_load_dwordx4 v[40:43], v3, s[40:43], s55 offen offset:0
    buffer_load_dwordx4 v[44:47], v3, s[40:43], s55 offen offset:32
    v_add_u32 v248, 4096, v2
    v_add_u32 v249, 8192, v2
    v_add_u32 v250, 12288, v2
k2_restart:
    s_mov_b32 s48, s46
    s_add_u32 s51, s46, 16384
    buffer_load_dwordx4 v[160:163], v2, s[40:43], s48 offen offset:0
    buffer_load_dwordx4 v[164:167], v2, s[40:43], s48 offen offset:1024
    buffer_load_dwordx4 v[168:171], v2, s[40:43], s48 offen offset:2048
    buffer_load_dwordx4 v[172:175], v2, s[40:43], s48 offen offset:3072
    s_and_b32 s13, s6, 1
    s_lshr_b32 s14, s6, 1
    s_lshl_b32 s15, s4, 1
    s_add_u32 s16, s15, s13
    s_xor_b32 s17, s16, 1
    s_mul_i32 s18, s3, 28672
    s_add_u32 s18, s18, 7077888
    s_mul_i32 s64, s16, 114688
    s_add_u32 s64, s64, s18
    s_mul_i32 s65, s17, 114688
    s_add_u32 s65, s65, s18
    s_lshl_b32 s15, s5, 1
    s_add_u32 s19, s15, s14
    s_xor_b32 s20, s19, 1
    s_mul_i32 s18, s3, 36864
    s_add_u32 s18, s18, 2359296
    s_mul_i32 s66, s19, 147456
    s_add_u32 s66, s66, s18
    s_mul_i32 s67, s20, 147456
    s_add_u32 s67, s67, s18
    s_cmp_lt_u32 s5, 7
    s_cselect_b32 s64, s64, 0x7fff0000
    s_cselect_b32 s65, s65, 0x7fff0000
    s_cselect_b32 s66, s66, 0x7fff0000
    s_cselect_b32 s67, s67, 0x7fff0000
    s_lshl_b32 s21, s5, 2
    s_add_u32 s21, s21, s3
    s_lshl_b32 s21, s21, 14
    s_add_u32 s21, s21, 6553600
    s_mul_i32 s61, s17, 28672
    s_lshl_b32 s62, s20, 6
    s_add_u32 s74, s61, s62
    v_mul_u32_u24 v7, 896, v6
    v_lshl_add_u32 v7, v5, 4, v7
    s_add_u32 s68, s64, 16384
    s_add_u32 s56, s46, 0
    s_add_u32 s69, s65, 16384
    s_add_u32 s57, s46, 16384
    s_add_u32 s70, s66, 16384
    s_add_u32 s58, s46, 32768
    s_add_u32 s71, s67, 16384
    s_add_u32 s59, s46, 49152
    s_xor_b32 s61, s6, 0
    s_mul_i32 s61, s61, 12288
    s_add_u32 s61, s61, 0
    v_add_u32 v251, s61, v2
    s_xor_b32 s61, s6, 1
    s_mul_i32 s61, s61, 12288
    s_add_u32 s61, s61, 4096
    v_add_u32 v252, s61, v2
    s_xor_b32 s61, s6, 2
    s_mul_i32 s61, s61, 12288
    s_add_u32 s61, s61, 8192
    v_add_u32 v253, s61, v2
    s_mul_i32 s61, s3, 12288
    v_add_u32 v254, s61, v2
    s_mov_b32 s22, 0x5e800000
    s_lshl_b32 s61, s3, 2
    s_add_u32 s61, s61, 98304
    v_mov_b32 v3, s61
    s_and_b32 s61, s7, 3
    s_lshl_b32 s61, s61, 3
    v_add_u32 v255, s61, v1
    v_lshl_add_u32 v255, v5, 5, v255
    v_lshlrev_b32 v255, 4, v255
    v_lshl_add_u32 v255, v4, 11, v255
    s_lshr_b32 s75, s7, 2
    s_lshl_b32 s75, s75, 15
    s_lshl_b32 s61, s3, 13
    s_add_u32 s61, s61, 4456448
    s_add_u32 s75, s75, s61
    s_lshl_b32 s76, s16, 15
    s_add_u32 s76, s76, s61
    s_lshl_b32 s77, s17, 15
    s_add_u32 s77, s77, s61
    s_mov_b32 s23, -2
    s_mov_b32 s80, 0
    s_mov_b32 s28, s8
    s_and_b32 s29, s9, 0xffff
    s_mov_b32 s30, 0x1c0000
    s_mov_b32 s31, 0x00020000
    s_mov_b32 s32, s10
    s_and_b32 s33, s11, 0xffff
    s_mov_b32 s34, 0x1c0000
    s_mov_b32 s35, 0x00020000
    s_waitcnt vmcnt(4)
    buffer_load_dwordx4 v[176:179], v248, s[40:43], s48 offen offset:0
    buffer_load_dwordx4 v[180:183], v248, s[40:43], s48 offen offset:1024
    buffer_load_dwordx4 v[184:187], v248, s[40:43], s48 offen offset:2048
    buffer_load_dwordx4 v[188:191], v248, s[40:43], s48 offen offset:3072
    buffer_load_dwordx4 v[192:195], v249, s[40:43], s48 offen offset:0
    buffer_load_dwordx4 v[196:199], v249, s[40:43], s48 offen offset:1024
    buffer_load_dwordx4 v[200:203], v249, s[40:43], s48 offen offset:2048
    buffer_load_dwordx4 v[204:207], v249, s[40:43], s48 offen offset:3072
    s_cmp_lg_u32 s60, 0
    s_cbranch_scc1 k2_skipm0
    s_waitcnt vmcnt(12)
    s_mov_b32 exec_lo, 0
    v_mov_b32 v22, 0
    v_mov_b32 v23, 0
    v_mov_b32 v30, 0
    v_mov_b32 v31, 0
    v_mov_b32 v38, 0
    v_mov_b32 v39, 0
    v_mov_b32 v46, 0
    v_mov_b32 v47, 0
    s_mov_b32 exec_lo, -1
    s_nop 0
    v_mfma_f32_32x32x16_bf16 v[112:127], v[208:211], v[16:19], 0
    v_mfma_f32_32x32x16_bf16 v[112:127], v[212:215], v[20:23], v[112:127]
    v_mfma_f32_32x32x16_bf16 v[128:143], v[208:211], v[24:27], 0
    v_mfma_f32_32x32x16_bf16 v[128:143], v[212:215], v[28:31], v[128:143]
    v_mfma_f32_32x32x16_bf16 v[224:239], v[208:211], v[32:35], 0
    v_mfma_f32_32x32x16_bf16 v[224:239], v[212:215], v[36:39], v[224:239]
    v_mfma_f32_32x32x16_bf16 v[48:63], v[208:211], v[40:43], 0
    v_mfma_f32_32x32x16_bf16 v[48:63], v[212:215], v[44:47], v[48:63]
    s_nop 5
    v_max_f32 v8, v112, v113
    v_max3_f32 v8, v8, v114, v115
    v_max3_f32 v8, v8, v116, v117
    v_max3_f32 v8, v8, v118, v119
    v_max3_f32 v8, v8, v120, v121
    v_max3_f32 v8, v8, v122, v123
    v_max3_f32 v8, v8, v124, v125
    v_max3_f32 v8, v8, v126, v127
    v_max_f32 v9, v128, v129
    v_max3_f32 v9, v9, v130, v131
    v_max3_f32 v9, v9, v132, v133
    v_max3_f32 v9, v9, v134, v135
    v_max3_f32 v9, v9, v136, v137
    v_max3_f32 v9, v9, v138, v139
    v_max3_f32 v9, v9, v140, v141
    v_max3_f32 v9, v9, v142, v143
    v_max_f32 v10, v224, v225
    v_max3_f32 v10, v10, v226, v227
    v_max3_f32 v10, v10, v228, v229
    v_max3_f32 v10, v10, v230, v231
    v_max3_f32 v10, v10, v232, v233
    v_max3_f32 v10, v10, v234, v235
    v_max3_f32 v10, v10, v236, v237
    v_max3_f32 v10, v10, v238, v239
    v_max_f32 v11, v48, v49
    v_max3_f32 v11, v11, v50, v51
    v_max3_f32 v11, v11, v52, v53
    v_max3_f32 v11, v11, v54, v55
    v_max3_f32 v11, v11, v56, v57
    v_max3_f32 v11, v11, v58, v59
    v_max3_f32 v11, v11, v60, v61
    v_max3_f32 v11, v11, v62, v63
    v_mov_b32 v12, v8
    v_mov_b32 v13, v9
    v_mov_b32 v14, v10
    v_mov_b32 v15, v11
    s_nop 0
    v_permlane32_swap_b32 v8, v12
    v_permlane32_swap_b32 v9, v13
    v_permlane32_swap_b32 v10, v14
    v_permlane32_swap_b32 v11, v15
    v_max_f32 v8, v8, v12
    v_max_f32 v9, v9, v13
    v_max_f32 v10, v10, v14
    v_max_f32 v11, v11, v15
    v_sub_f32 v8, 0xc2800000, v8
    v_sub_f32 v9, 0xc2800000, v9
    v_sub_f32 v10, 0xc2800000, v10
    v_sub_f32 v11, 0xc2800000, v11
    v_and_b32 v144, s72, v8
    v_and_b32 v146, s72, v9
    v_and_b32 v148, s72, v10
    v_and_b32 v150, s72, v11
    v_sub_f32 v8, v8, v144
    v_sub_f32 v9, v9, v146
    v_sub_f32 v10, v10, v148
    v_sub_f32 v11, v11, v150
    v_and_b32 v145, s72, v8
    v_and_b32 v147, s72, v9
    v_and_b32 v149, s72, v10
    v_and_b32 v151, s72, v11
    v_sub_f32 v8, v8, v145
    v_sub_f32 v9, v9, v147
    v_sub_f32 v10, v10, v149
    v_sub_f32 v11, v11, v151
    s_mov_b32 exec_lo, 0
    v_perm_b32 v22, v145, v144, s73
    v_lshrrev_b32 v23, 16, v8
    v_perm_b32 v30, v147, v146, s73
    v_lshrrev_b32 v31, 16, v9
    v_perm_b32 v38, v149, v148, s73
    v_lshrrev_b32 v39, 16, v10
    v_perm_b32 v46, v151, v150, s73
    v_lshrrev_b32 v47, 16, v11
    s_mov_b32 exec_lo, -1
k2_skipm0:
    s_waitcnt vmcnt(10)
    v_mfma_f32_32x32x16_bf16 v[112:127], v[160:163], v[16:19], 0
    v_mfma_f32_32x32x16_bf16 v[112:127], v[164:167], v[20:23], v[112:127]
    v_mfma_f32_32x32x16_bf16 v[128:143], v[160:163], v[24:27], 0
    buffer_load_dwordx4 a[64:67], v2, s[40:43], s64 offen offset:0
    v_exp_f32 v112, v112
    v_exp_f32 v113, v113
    v_exp_f32 v114, v114
    v_cvt_pk_bf16_f32 v144, v112, v113
    v_exp_f32 v115, v115
    v_exp_f32 v116, v116
    v_cvt_pk_bf16_f32 v145, v114, v115
    v_exp_f32 v117, v117
    v_exp_f32 v118, v118
    v_cvt_pk_bf16_f32 v146, v116, v117
    v_exp_f32 v119, v119
    v_exp_f32 v120, v120
    v_mfma_f32_32x32x16_bf16 v[128:143], v[164:167], v[28:31], v[128:143]
    buffer_load_dwordx4 a[68:71], v2, s[40:43], s65 offen offset:0
    v_cvt_pk_bf16_f32 v147, v118, v119
    v_exp_f32 v121, v121
    v_exp_f32 v122, v122
    v_cvt_pk_bf16_f32 v148, v120, v121
    v_exp_f32 v123, v123
    v_exp_f32 v124, v124
    v_cvt_pk_bf16_f32 v149, v122, v123
    v_exp_f32 v125, v125
    v_exp_f32 v126, v126
    v_exp_f32 v127, v127
    v_cvt_pk_bf16_f32 v150, v124, v125
    v_cvt_pk_bf16_f32 v151, v126, v127
    v_mfma_f32_32x32x16_bf16 v[112:127], v[160:163], v[32:35], 0
    buffer_load_dwordx4 v[208:211], v250, s[40:43], s56 offen offset:0
    v_exp_f32 v128, v128
    v_exp_f32 v129, v129
    v_exp_f32 v130, v130
    v_cvt_pk_bf16_f32 v152, v128, v129
    v_exp_f32 v131, v131
    v_exp_f32 v132, v132
    v_mfma_f32_32x32x16_bf16 v[112:127], v[164:167], v[36:39], v[112:127]
    buffer_load_dwordx4 v[212:215], v250, s[40:43], s56 offen offset:1024
    v_cvt_pk_bf16_f32 v153, v130, v131
    v_exp_f32 v133, v133
    v_exp_f32 v134, v134
    v_cvt_pk_bf16_f32 v154, v132, v133
    v_exp_f32 v135, v135
    v_exp_f32 v136, v136
    s_waitcnt vmcnt(13)
    v_mfma_f32_32x32x16_bf16 v[48:63], v[168:171], v[144:147], 0
    buffer_load_dwordx4 v[216:219], v250, s[40:43], s56 offen offset:2048
    v_cvt_pk_bf16_f32 v155, v134, v135
    v_exp_f32 v137, v137
    v_exp_f32 v138, v138
    v_cvt_pk_bf16_f32 v156, v136, v137
    v_exp_f32 v139, v139
    v_exp_f32 v140, v140
    s_waitcnt vmcnt(13)
    v_mfma_f32_32x32x16_bf16 v[48:63], v[172:175], v[148:151], v[48:63]
    buffer_load_dwordx4 v[220:223], v250, s[40:43], s56 offen offset:3072
    v_cvt_pk_bf16_f32 v157, v138, v139
    v_exp_f32 v141, v141
    v_exp_f32 v142, v142
    v_exp_f32 v143, v143
    v_cvt_pk_bf16_f32 v158, v140, v141
    v_cvt_pk_bf16_f32 v159, v142, v143
    v_mfma_f32_32x32x16_bf16 v[128:143], v[160:163], v[40:43], 0
    buffer_load_dwordx4 a[72:75], v2, s[40:43], s66 offen offset:0
    v_exp_f32 v112, v112
    v_exp_f32 v113, v113
    v_exp_f32 v114, v114
    v_cvt_pk_bf16_f32 v144, v112, v113
    v_exp_f32 v115, v115
    v_exp_f32 v116, v116
    v_mfma_f32_32x32x16_bf16 v[128:143], v[164:167], v[44:47], v[128:143]
    buffer_load_dwordx4 a[76:79], v2, s[40:43], s67 offen offset:0
    v_cvt_pk_bf16_f32 v145, v114, v115
    v_exp_f32 v117, v117
    v_exp_f32 v118, v118
    v_cvt_pk_bf16_f32 v146, v116, v117
    v_exp_f32 v119, v119
    v_exp_f32 v120, v120
    v_mfma_f32_32x32x16_bf16 v[64:79], v[168:171], v[152:155], 0
    v_cvt_pk_bf16_f32 v147, v118, v119
    v_exp_f32 v121, v121
    v_exp_f32 v122, v122
    v_cvt_pk_bf16_f32 v148, v120, v121
    v_exp_f32 v123, v123
    v_exp_f32 v124, v124
    v_mfma_f32_32x32x16_bf16 v[64:79], v[172:175], v[156:159], v[64:79]
    v_cvt_pk_bf16_f32 v149, v122, v123
    v_exp_f32 v125, v125
    v_exp_f32 v126, v126
    v_exp_f32 v127, v127
    v_cvt_pk_bf16_f32 v150, v124, v125
    v_cvt_pk_bf16_f32 v151, v126, v127
    s_waitcnt vmcnt(15)
    v_mfma_f32_32x32x16_bf16 v[112:127], v[176:179], v[16:19], 0
    buffer_load_dwordx4 a[80:83], v2, s[40:43], s64 offen offset:1024
    v_exp_f32 v128, v128
    v_exp_f32 v129, v129
    v_exp_f32 v130, v130
    v_cvt_pk_bf16_f32 v152, v128, v129
    v_exp_f32 v131, v131
    v_exp_f32 v132, v132
    s_waitcnt vmcnt(15)
    v_mfma_f32_32x32x16_bf16 v[112:127], v[180:183], v[20:23], v[112:127]
    buffer_load_dwordx4 a[84:87], v2, s[40:43], s65 offen offset:1024
    v_cvt_pk_bf16_f32 v153, v130, v131
    v_exp_f32 v133, v133
    v_exp_f32 v134, v134
    v_cvt_pk_bf16_f32 v154, v132, v133
    v_exp_f32 v135, v135
    v_exp_f32 v136, v136
    v_mfma_f32_32x32x16_bf16 v[80:95], v[168:171], v[144:147], 0
    v_cvt_pk_bf16_f32 v155, v134, v135
    v_exp_f32 v137, v137
    v_exp_f32 v138, v138
    v_cvt_pk_bf16_f32 v156, v136, v137
    v_exp_f32 v139, v139
    v_exp_f32 v140, v140
    v_mfma_f32_32x32x16_bf16 v[80:95], v[172:175], v[148:151], v[80:95]
    v_cvt_pk_bf16_f32 v157, v138, v139
    v_exp_f32 v141, v141
    v_exp_f32 v142, v142
    v_exp_f32 v143, v143
    v_cvt_pk_bf16_f32 v158, v140, v141
    v_cvt_pk_bf16_f32 v159, v142, v143
    v_mfma_f32_32x32x16_bf16 v[128:143], v[176:179], v[24:27], 0
    buffer_load_dwordx4 a[88:91], v2, s[40:43], s66 offen offset:1024
    v_exp_f32 v112, v112
    v_exp_f32 v113, v113
    v_exp_f32 v114, v114
    v_cvt_pk_bf16_f32 v144, v112, v113
    v_exp_f32 v115, v115
    v_exp_f32 v116, v116
    v_mfma_f32_32x32x16_bf16 v[128:143], v[180:183], v[28:31], v[128:143]
    buffer_load_dwordx4 a[92:95], v2, s[40:43], s67 offen offset:1024
    v_cvt_pk_bf16_f32 v145, v114, v115
    v_exp_f32 v117, v117
    v_exp_f32 v118, v118
    v_cvt_pk_bf16_f32 v146, v116, v117
    v_exp_f32 v119, v119
    v_exp_f32 v120, v120
    v_mfma_f32_32x32x16_bf16 v[96:111], v[168:171], v[152:155], 0
    v_cvt_pk_bf16_f32 v147, v118, v119
    v_exp_f32 v121, v121
    v_exp_f32 v122, v122
    v_cvt_pk_bf16_f32 v148, v120, v121
    v_exp_f32 v123, v123
    v_exp_f32 v124, v124
    v_mfma_f32_32x32x16_bf16 v[96:111], v[172:175], v[156:159], v[96:111]
    v_cvt_pk_bf16_f32 v149, v122, v123
    v_exp_f32 v125, v125
    v_exp_f32 v126, v126
    v_exp_f32 v127, v127
    v_cvt_pk_bf16_f32 v150, v124, v125
    v_cvt_pk_bf16_f32 v151, v126, v127
    v_mfma_f32_32x32x16_bf16 v[112:127], v[176:179], v[32:35], 0
    buffer_load_dwordx4 v[160:163], v2, s[40:43], s57 offen offset:0
    v_exp_f32 v128, v128
    v_exp_f32 v129, v129
    v_exp_f32 v130, v130
    v_cvt_pk_bf16_f32 v152, v128, v129
    v_exp_f32 v131, v131
    v_exp_f32 v132, v132
    v_mfma_f32_32x32x16_bf16 v[112:127], v[180:183], v[36:39], v[112:127]
    buffer_load_dwordx4 v[164:167], v2, s[40:43], s57 offen offset:1024
    v_cvt_pk_bf16_f32 v153, v130, v131
    v_exp_f32 v133, v133
    v_exp_f32 v134, v134
    v_cvt_pk_bf16_f32 v154, v132, v133
    v_exp_f32 v135, v135
    v_exp_f32 v136, v136
    s_waitcnt vmcnt(19)
    v_mfma_f32_32x32x16_bf16 v[48:63], v[184:187], v[144:147], v[48:63]
    buffer_load_dwordx4 v[168:171], v2, s[40:43], s57 offen offset:2048
    v_cvt_pk_bf16_f32 v155, v134, v135
    v_exp_f32 v137, v137
    v_exp_f32 v138, v138
    v_cvt_pk_bf16_f32 v156, v136, v137
    v_exp_f32 v139, v139
    v_exp_f32 v140, v140
    s_waitcnt vmcnt(19)
    v_mfma_f32_32x32x16_bf16 v[48:63], v[188:191], v[148:151], v[48:63]
    buffer_load_dwordx4 v[172:175], v2, s[40:43], s57 offen offset:3072
    v_cvt_pk_bf16_f32 v157, v138, v139
    v_exp_f32 v141, v141
    v_exp_f32 v142, v142
    v_exp_f32 v143, v143
    v_cvt_pk_bf16_f32 v158, v140, v141
    v_cvt_pk_bf16_f32 v159, v142, v143
    v_mfma_f32_32x32x16_bf16 v[128:143], v[176:179], v[40:43], 0
    buffer_load_dwordx4 a[96:99], v2, s[40:43], s64 offen offset:2048
    v_exp_f32 v112, v112
    v_exp_f32 v113, v113
    v_exp_f32 v114, v114
    v_cvt_pk_bf16_f32 v144, v112, v113
    v_exp_f32 v115, v115
    v_exp_f32 v116, v116
    v_mfma_f32_32x32x16_bf16 v[128:143], v[180:183], v[44:47], v[128:143]
    buffer_load_dwordx4 a[100:103], v2, s[40:43], s65 offen offset:2048
    v_cvt_pk_bf16_f32 v145, v114, v115
    v_exp_f32 v117, v117
    v_exp_f32 v118, v118
    v_cvt_pk_bf16_f32 v146, v116, v117
    v_exp_f32 v119, v119
    v_exp_f32 v120, v120
    v_mfma_f32_32x32x16_bf16 v[64:79], v[184:187], v[152:155], v[64:79]
    v_cvt_pk_bf16_f32 v147, v118, v119
    v_exp_f32 v121, v121
    v_exp_f32 v122, v122
    v_cvt_pk_bf16_f32 v148, v120, v121
    v_exp_f32 v123, v123
    v_exp_f32 v124, v124
    v_mfma_f32_32x32x16_bf16 v[64:79], v[188:191], v[156:159], v[64:79]
    v_cvt_pk_bf16_f32 v149, v122, v123
    v_exp_f32 v125, v125
    v_exp_f32 v126, v126
    v_exp_f32 v127, v127
    v_cvt_pk_bf16_f32 v150, v124, v125
    v_cvt_pk_bf16_f32 v151, v126, v127
    s_waitcnt vmcnt(20)
    v_mfma_f32_32x32x16_bf16 v[112:127], v[192:195], v[16:19], 0
    buffer_load_dwordx4 a[104:107], v2, s[40:43], s66 offen offset:2048
    v_exp_f32 v128, v128
    v_exp_f32 v129, v129
    v_exp_f32 v130, v130
    v_cvt_pk_bf16_f32 v152, v128, v129
    v_exp_f32 v131, v131
    v_exp_f32 v132, v132
    v_mfma_f32_32x32x16_bf16 v[112:127], v[196:199], v[20:23], v[112:127]
    buffer_load_dwordx4 a[108:111], v2, s[40:43], s67 offen offset:2048
    v_cvt_pk_bf16_f32 v153, v130, v131
    v_exp_f32 v133, v133
    v_exp_f32 v134, v134
    v_cvt_pk_bf16_f32 v154, v132, v133
    v_exp_f32 v135, v135
    v_exp_f32 v136, v136
    v_mfma_f32_32x32x16_bf16 v[80:95], v[184:187], v[144:147], v[80:95]
    v_cvt_pk_bf16_f32 v155, v134, v135
    v_exp_f32 v137, v137
    v_exp_f32 v138, v138
    v_cvt_pk_bf16_f32 v156, v136, v137
    v_exp_f32 v139, v139
    v_exp_f32 v140, v140
    v_mfma_f32_32x32x16_bf16 v[80:95], v[188:191], v[148:151], v[80:95]
    v_cvt_pk_bf16_f32 v157, v138, v139
    v_exp_f32 v141, v141
    v_exp_f32 v142, v142
    v_exp_f32 v143, v143
    v_cvt_pk_bf16_f32 v158, v140, v141
    v_cvt_pk_bf16_f32 v159, v142, v143
    v_mfma_f32_32x32x16_bf16 v[128:143], v[192:195], v[24:27], 0
    buffer_load_dwordx4 a[112:115], v2, s[40:43], s64 offen offset:3072
    v_exp_f32 v112, v112
    v_exp_f32 v113, v113
    v_exp_f32 v114, v114
    v_cvt_pk_bf16_f32 v144, v112, v113
    v_exp_f32 v115, v115
    v_exp_f32 v116, v116
    v_mfma_f32_32x32x16_bf16 v[128:143], v[196:199], v[28:31], v[128:143]
    buffer_load_dwordx4 a[116:119], v2, s[40:43], s65 offen offset:3072
    v_cvt_pk_bf16_f32 v145, v114, v115
    v_exp_f32 v117, v117
    v_exp_f32 v118, v118
    v_cvt_pk_bf16_f32 v146, v116, v117
    v_exp_f32 v119, v119
    v_exp_f32 v120, v120
    v_mfma_f32_32x32x16_bf16 v[96:111], v[184:187], v[152:155], v[96:111]
    v_cvt_pk_bf16_f32 v147, v118, v119
    v_exp_f32 v121, v121
    v_exp_f32 v122, v122
    v_cvt_pk_bf16_f32 v148, v120, v121
    v_exp_f32 v123, v123
    v_exp_f32 v124, v124
    v_mfma_f32_32x32x16_bf16 v[96:111], v[188:191], v[156:159], v[96:111]
    v_cvt_pk_bf16_f32 v149, v122, v123
    v_exp_f32 v125, v125
    v_exp_f32 v126, v126
    v_exp_f32 v127, v127
    v_cvt_pk_bf16_f32 v150, v124, v125
    v_cvt_pk_bf16_f32 v151, v126, v127
    v_mfma_f32_32x32x16_bf16 v[112:127], v[192:195], v[32:35], 0
    buffer_load_dwordx4 v[176:179], v248, s[40:43], s57 offen offset:0
    v_exp_f32 v128, v128
    v_exp_f32 v129, v129
    v_exp_f32 v130, v130
    v_cvt_pk_bf16_f32 v152, v128, v129
    v_exp_f32 v131, v131
    v_exp_f32 v132, v132
    v_mfma_f32_32x32x16_bf16 v[112:127], v[196:199], v[36:39], v[112:127]
    buffer_load_dwordx4 v[180:183], v248, s[40:43], s57 offen offset:1024
    v_cvt_pk_bf16_f32 v153, v130, v131
    v_exp_f32 v133, v133
    v_exp_f32 v134, v134
    v_cvt_pk_bf16_f32 v154, v132, v133
    v_exp_f32 v135, v135
    v_exp_f32 v136, v136
    s_waitcnt vmcnt(20)
    v_mfma_f32_32x32x16_bf16 v[48:63], v[200:203], v[144:147], v[48:63]
    buffer_load_dwordx4 v[184:187], v248, s[40:43], s57 offen offset:2048
    v_cvt_pk_bf16_f32 v155, v134, v135
    v_exp_f32 v137, v137
    v_exp_f32 v138, v138
    v_cvt_pk_bf16_f32 v156, v136, v137
    v_exp_f32 v139, v139
    v_exp_f32 v140, v140
    v_mfma_f32_32x32x16_bf16 v[48:63], v[204:207], v[148:151], v[48:63]
    buffer_load_dwordx4 v[188:191], v248, s[40:43], s57 offen offset:3072
    v_cvt_pk_bf16_f32 v157, v138, v139
    v_exp_f32 v141, v141
    v_exp_f32 v142, v142
    v_exp_f32 v143, v143
    v_cvt_pk_bf16_f32 v158, v140, v141
    v_cvt_pk_bf16_f32 v159, v142, v143
    v_mfma_f32_32x32x16_bf16 v[128:143], v[192:195], v[40:43], 0
    buffer_load_dwordx4 a[120:123], v2, s[40:43], s66 offen offset:3072
    v_exp_f32 v112, v112
    v_exp_f32 v113, v113
    v_exp_f32 v114, v114
    v_cvt_pk_bf16_f32 v144, v112, v113
    v_exp_f32 v115, v115
    v_exp_f32 v116, v116
    v_mfma_f32_32x32x16_bf16 v[128:143], v[196:199], v[44:47], v[128:143]
    buffer_load_dwordx4 a[124:127], v2, s[40:43], s67 offen offset:3072
    v_cvt_pk_bf16_f32 v145, v114, v115
    v_exp_f32 v117, v117
    v_exp_f32 v118, v118
    v_cvt_pk_bf16_f32 v146, v116, v117
    v_exp_f32 v119, v119
    v_exp_f32 v120, v120
    v_mfma_f32_32x32x16_bf16 v[64:79], v[200:203], v[152:155], v[64:79]
    v_cvt_pk_bf16_f32 v147, v118, v119
    v_exp_f32 v121, v121
    v_exp_f32 v122, v122
    v_cvt_pk_bf16_f32 v148, v120, v121
    v_exp_f32 v123, v123
    v_exp_f32 v124, v124
    v_mfma_f32_32x32x16_bf16 v[64:79], v[204:207], v[156:159], v[64:79]
    v_cvt_pk_bf16_f32 v149, v122, v123
    v_exp_f32 v125, v125
    v_exp_f32 v126, v126
    v_exp_f32 v127, v127
    v_cvt_pk_bf16_f32 v150, v124, v125
    v_cvt_pk_bf16_f32 v151, v126, v127
    v_mfma_f32_32x32x16_bf16 v[112:127], v[208:211], v[16:19], 0
    buffer_load_dwordx4 a[128:131], v248, s[40:43], s64 offen offset:0
    v_exp_f32 v128, v128
    v_exp_f32 v129, v129
    v_exp_f32 v130, v130
    v_cvt_pk_bf16_f32 v152, v128, v129
    v_exp_f32 v131, v131
    v_exp_f32 v132, v132
    v_mfma_f32_32x32x16_bf16 v[112:127], v[212:215], v[20:23], v[112:127]
    buffer_load_dwordx4 a[132:135], v248, s[40:43], s65 offen offset:0
    v_cvt_pk_bf16_f32 v153, v130, v131
    v_exp_f32 v133, v133
    v_exp_f32 v134, v134
    v_cvt_pk_bf16_f32 v154, v132, v133
    v_exp_f32 v135, v135
    v_exp_f32 v136, v136
    v_mfma_f32_32x32x16_bf16 v[80:95], v[200:203], v[144:147], v[80:95]
    v_cvt_pk_bf16_f32 v155, v134, v135
    v_exp_f32 v137, v137
    v_exp_f32 v138, v138
    v_cvt_pk_bf16_f32 v156, v136, v137
    v_exp_f32 v139, v139
    v_exp_f32 v140, v140
    v_mfma_f32_32x32x16_bf16 v[80:95], v[204:207], v[148:151], v[80:95]
    v_cvt_pk_bf16_f32 v157, v138, v139
    v_exp_f32 v141, v141
    v_exp_f32 v142, v142
    v_exp_f32 v143, v143
    v_cvt_pk_bf16_f32 v158, v140, v141
    v_cvt_pk_bf16_f32 v159, v142, v143
    v_mfma_f32_32x32x16_bf16 v[128:143], v[208:211], v[24:27], 0
    buffer_load_dwordx4 a[136:139], v248, s[40:43], s66 offen offset:0
    v_exp_f32 v112, v112
    v_exp_f32 v113, v113
    v_exp_f32 v114, v114
    v_cvt_pk_bf16_f32 v144, v112, v113
    s_waitcnt vmcnt(23)
    v_mfma_f32_32x32x16_bf16 a[0:15], a[72:75], a[64:67], 0
    buffer_load_dwordx4 a[140:143], v248, s[40:43], s67 offen offset:0
    v_exp_f32 v115, v115
    v_exp_f32 v116, v116
    v_cvt_pk_bf16_f32 v145, v114, v115
    v_exp_f32 v117, v117
    v_mfma_f32_32x32x16_bf16 v[128:143], v[212:215], v[28:31], v[128:143]
    v_exp_f32 v118, v118
    v_cvt_pk_bf16_f32 v146, v116, v117
    v_exp_f32 v119, v119
    v_exp_f32 v120, v120
    v_mfma_f32_32x32x16_bf16 v[96:111], v[200:203], v[152:155], v[96:111]
    v_cvt_pk_bf16_f32 v147, v118, v119
    v_exp_f32 v121, v121
    v_exp_f32 v122, v122
    v_cvt_pk_bf16_f32 v148, v120, v121
    v_mfma_f32_32x32x16_bf16 a[16:31], a[72:75], a[68:71], 0
    v_exp_f32 v123, v123
    v_exp_f32 v124, v124
    v_cvt_pk_bf16_f32 v149, v122, v123
    v_exp_f32 v125, v125
    v_mfma_f32_32x32x16_bf16 v[96:111], v[204:207], v[156:159], v[96:111]
    v_exp_f32 v126, v126
    v_exp_f32 v127, v127
    v_cvt_pk_bf16_f32 v150, v124, v125
    v_cvt_pk_bf16_f32 v151, v126, v127
    v_mfma_f32_32x32x16_bf16 v[112:127], v[208:211], v[32:35], 0
    buffer_load_dwordx4 v[192:195], v249, s[40:43], s57 offen offset:0
    v_exp_f32 v128, v128
    v_exp_f32 v129, v129
    v_exp_f32 v130, v130
    v_cvt_pk_bf16_f32 v152, v128, v129
    v_exp_f32 v131, v131
    v_mfma_f32_32x32x16_bf16 v[112:127], v[212:215], v[36:39], v[112:127]
    buffer_load_dwordx4 v[196:199], v249, s[40:43], s57 offen offset:1024
    v_exp_f32 v132, v132
    v_cvt_pk_bf16_f32 v153, v130, v131
    v_exp_f32 v133, v133
    v_exp_f32 v134, v134
    v_mfma_f32_32x32x16_bf16 a[32:47], a[76:79], a[64:67], 0
    buffer_load_dwordx4 v[200:203], v249, s[40:43], s57 offen offset:2048
    v_cvt_pk_bf16_f32 v154, v132, v133
    v_exp_f32 v135, v135
    v_exp_f32 v136, v136
    v_cvt_pk_bf16_f32 v155, v134, v135
    v_exp_f32 v137, v137
    v_mfma_f32_32x32x16_bf16 v[48:63], v[216:219], v[144:147], v[48:63]
    buffer_load_dwordx4 v[204:207], v249, s[40:43], s57 offen offset:3072
    v_exp_f32 v138, v138
    v_cvt_pk_bf16_f32 v156, v136, v137
    v_exp_f32 v139, v139
    v_exp_f32 v140, v140
    v_cvt_pk_bf16_f32 v157, v138, v139
    v_mfma_f32_32x32x16_bf16 v[48:63], v[220:223], v[148:151], v[48:63]
    v_exp_f32 v141, v141
    v_exp_f32 v142, v142
    v_exp_f32 v143, v143
    v_cvt_pk_bf16_f32 v158, v140, v141
    v_cvt_pk_bf16_f32 v159, v142, v143
    v_mfma_f32_32x32x16_bf16 v[128:143], v[208:211], v[40:43], 0
    buffer_load_dwordx4 a[144:147], v248, s[40:43], s64 offen offset:1024
    v_exp_f32 v112, v112
    v_exp_f32 v113, v113
    v_exp_f32 v114, v114
    v_cvt_pk_bf16_f32 v144, v112, v113
    v_exp_f32 v115, v115
    v_mfma_f32_32x32x16_bf16 v[128:143], v[212:215], v[44:47], v[128:143]
    buffer_load_dwordx4 a[148:151], v248, s[40:43], s65 offen offset:1024
    v_exp_f32 v116, v116
    v_cvt_pk_bf16_f32 v145, v114, v115
    v_exp_f32 v117, v117
    v_exp_f32 v118, v118
    v_mfma_f32_32x32x16_bf16 a[48:63], a[76:79], a[68:71], 0
    v_cvt_pk_bf16_f32 v146, v116, v117
    v_exp_f32 v119, v119
    v_exp_f32 v120, v120
    v_cvt_pk_bf16_f32 v147, v118, v119
    v_exp_f32 v121, v121
    v_mfma_f32_32x32x16_bf16 v[64:79], v[216:219], v[152:155], v[64:79]
    v_exp_f32 v122, v122
    v_cvt_pk_bf16_f32 v148, v120, v121
    v_exp_f32 v123, v123
    v_exp_f32 v124, v124
    v_cvt_pk_bf16_f32 v149, v122, v123
    v_mfma_f32_32x32x16_bf16 v[64:79], v[220:223], v[156:159], v[64:79]
    v_exp_f32 v125, v125
    v_exp_f32 v126, v126
    v_exp_f32 v127, v127
    v_cvt_pk_bf16_f32 v150, v124, v125
    v_cvt_pk_bf16_f32 v151, v126, v127
    s_waitcnt vmcnt(22)
    v_mfma_f32_32x32x16_bf16 v[112:127], v[160:163], v[16:19], 0
    buffer_load_dwordx4 a[152:155], v248, s[40:43], s66 offen offset:1024
    v_exp_f32 v128, v128
    v_exp_f32 v129, v129
    v_exp_f32 v130, v130
    v_cvt_pk_bf16_f32 v152, v128, v129
    v_exp_f32 v131, v131
    v_mfma_f32_32x32x16_bf16 v[112:127], v[164:167], v[20:23], v[112:127]
    buffer_load_dwordx4 a[156:159], v248, s[40:43], s67 offen offset:1024
    v_exp_f32 v132, v132
    v_cvt_pk_bf16_f32 v153, v130, v131
    v_exp_f32 v133, v133
    v_exp_f32 v134, v134
    v_mfma_f32_32x32x16_bf16 a[0:15], a[88:91], a[80:83], a[0:15]
    v_cvt_pk_bf16_f32 v154, v132, v133
    v_exp_f32 v135, v135
    v_exp_f32 v136, v136
    v_cvt_pk_bf16_f32 v155, v134, v135
    v_exp_f32 v137, v137
    v_mfma_f32_32x32x16_bf16 v[80:95], v[216:219], v[144:147], v[80:95]
    v_exp_f32 v138, v138
    v_cvt_pk_bf16_f32 v156, v136, v137
    v_exp_f32 v139, v139
    v_exp_f32 v140, v140
    v_cvt_pk_bf16_f32 v157, v138, v139
    v_mfma_f32_32x32x16_bf16 v[80:95], v[220:223], v[148:151], v[80:95]
    v_exp_f32 v141, v141
    v_exp_f32 v142, v142
    v_exp_f32 v143, v143
    v_cvt_pk_bf16_f32 v158, v140, v141
    v_cvt_pk_bf16_f32 v159, v142, v143
    v_mfma_f32_32x32x16_bf16 v[128:143], v[160:163], v[24:27], 0
    buffer_load_dwordx4 a[160:163], v248, s[40:43], s64 offen offset:2048
    v_exp_f32 v112, v112
    v_exp_f32 v113, v113
    v_exp_f32 v114, v114
    v_cvt_pk_bf16_f32 v144, v112, v113
    v_exp_f32 v115, v115
    v_mfma_f32_32x32x16_bf16 v[128:143], v[164:167], v[28:31], v[128:143]
    buffer_load_dwordx4 a[164:167], v248, s[40:43], s65 offen offset:2048
    v_exp_f32 v116, v116
    v_cvt_pk_bf16_f32 v145, v114, v115
    v_exp_f32 v117, v117
    v_exp_f32 v118, v118
    v_mfma_f32_32x32x16_bf16 a[16:31], a[88:91], a[84:87], a[16:31]
    v_cvt_pk_bf16_f32 v146, v116, v117
    v_exp_f32 v119, v119
    v_exp_f32 v120, v120
    v_cvt_pk_bf16_f32 v147, v118, v119
    v_exp_f32 v121, v121
    v_mfma_f32_32x32x16_bf16 v[96:111], v[216:219], v[152:155], v[96:111]
    v_exp_f32 v122, v122
    v_cvt_pk_bf16_f32 v148, v120, v121
    v_exp_f32 v123, v123
    v_exp_f32 v124, v124
    v_cvt_pk_bf16_f32 v149, v122, v123
    v_mfma_f32_32x32x16_bf16 v[96:111], v[220:223], v[156:159], v[96:111]
    v_exp_f32 v125, v125
    v_exp_f32 v126, v126
    v_exp_f32 v127, v127
    v_cvt_pk_bf16_f32 v150, v124, v125
    v_cvt_pk_bf16_f32 v151, v126, v127
    v_mfma_f32_32x32x16_bf16 v[112:127], v[160:163], v[32:35], 0
    buffer_load_dwordx4 v[208:211], v250, s[40:43], s57 offen offset:0
    v_exp_f32 v128, v128
    v_exp_f32 v129, v129
    v_exp_f32 v130, v130
    v_cvt_pk_bf16_f32 v152, v128, v129
    v_exp_f32 v131, v131
    v_mfma_f32_32x32x16_bf16 v[112:127], v[164:167], v[36:39], v[112:127]
    buffer_load_dwordx4 v[212:215], v250, s[40:43], s57 offen offset:1024
    v_exp_f32 v132, v132
    v_cvt_pk_bf16_f32 v153, v130, v131
    v_exp_f32 v133, v133
    v_exp_f32 v134, v134
    v_mfma_f32_32x32x16_bf16 a[32:47], a[92:95], a[80:83], a[32:47]
    buffer_load_dwordx4 v[216:219], v250, s[40:43], s57 offen offset:2048
    v_cvt_pk_bf16_f32 v154, v132, v133
    v_exp_f32 v135, v135
    v_exp_f32 v136, v136
    v_cvt_pk_bf16_f32 v155, v134, v135
    v_exp_f32 v137, v137
    v_mfma_f32_32x32x16_bf16 v[48:63], v[168:171], v[144:147], v[48:63]
    buffer_load_dwordx4 v[220:223], v250, s[40:43], s57 offen offset:3072
    v_exp_f32 v138, v138
    v_cvt_pk_bf16_f32 v156, v136, v137
    v_exp_f32 v139, v139
    v_exp_f32 v140, v140
    v_cvt_pk_bf16_f32 v157, v138, v139
    v_mfma_f32_32x32x16_bf16 v[48:63], v[172:175], v[148:151], v[48:63]
    v_exp_f32 v141, v141
    v_exp_f32 v142, v142
    v_exp_f32 v143, v143
    v_cvt_pk_bf16_f32 v158, v140, v141
    v_cvt_pk_bf16_f32 v159, v142, v143
    v_mfma_f32_32x32x16_bf16 v[128:143], v[160:163], v[40:43], 0
    buffer_load_dwordx4 a[168:171], v248, s[40:43], s66 offen offset:2048
    v_exp_f32 v112, v112
    v_exp_f32 v113, v113
    v_exp_f32 v114, v114
    v_cvt_pk_bf16_f32 v144, v112, v113
    v_exp_f32 v115, v115
    v_mfma_f32_32x32x16_bf16 v[128:143], v[164:167], v[44:47], v[128:143]
    buffer_load_dwordx4 a[172:175], v248, s[40:43], s67 offen offset:2048
    v_exp_f32 v116, v116
    v_cvt_pk_bf16_f32 v145, v114, v115
    v_exp_f32 v117, v117
    v_exp_f32 v118, v118
    v_mfma_f32_32x32x16_bf16 a[48:63], a[92:95], a[84:87], a[48:63]
    v_cvt_pk_bf16_f32 v146, v116, v117
    v_exp_f32 v119, v119
    v_exp_f32 v120, v120
    v_cvt_pk_bf16_f32 v147, v118, v119
    v_exp_f32 v121, v121
    v_mfma_f32_32x32x16_bf16 v[64:79], v[168:171], v[152:155], v[64:79]
    v_exp_f32 v122, v122
    v_cvt_pk_bf16_f32 v148, v120, v121
    v_exp_f32 v123, v123
    v_exp_f32 v124, v124
    v_cvt_pk_bf16_f32 v149, v122, v123
    v_mfma_f32_32x32x16_bf16 v[64:79], v[172:175], v[156:159], v[64:79]
    v_exp_f32 v125, v125
    v_exp_f32 v126, v126
    v_exp_f32 v127, v127
    v_cvt_pk_bf16_f32 v150, v124, v125
    v_cvt_pk_bf16_f32 v151, v126, v127
    s_waitcnt vmcnt(22)
    v_mfma_f32_32x32x16_bf16 v[112:127], v[176:179], v[16:19], 0
    buffer_load_dwordx4 a[192:195], v248, s[40:43], s64 offen offset:3072
    v_exp_f32 v128, v128
    v_exp_f32 v129, v129
    v_exp_f32 v130, v130
    v_cvt_pk_bf16_f32 v152, v128, v129
    v_exp_f32 v131, v131
    v_mfma_f32_32x32x16_bf16 v[112:127], v[180:183], v[20:23], v[112:127]
    buffer_load_dwordx4 a[196:199], v248, s[40:43], s65 offen offset:3072
    v_exp_f32 v132, v132
    v_cvt_pk_bf16_f32 v153, v130, v131
    v_exp_f32 v133, v133
    v_exp_f32 v134, v134
    v_mfma_f32_32x32x16_bf16 a[0:15], a[104:107], a[96:99], a[0:15]
    v_cvt_pk_bf16_f32 v154, v132, v133
    v_exp_f32 v135, v135
    v_exp_f32 v136, v136
    v_cvt_pk_bf16_f32 v155, v134, v135
    v_exp_f32 v137, v137
    v_mfma_f32_32x32x16_bf16 v[80:95], v[168:171], v[144:147], v[80:95]
    v_exp_f32 v138, v138
    v_cvt_pk_bf16_f32 v156, v136, v137
    v_exp_f32 v139, v139
    v_exp_f32 v140, v140
    v_cvt_pk_bf16_f32 v157, v138, v139
    v_mfma_f32_32x32x16_bf16 v[80:95], v[172:175], v[148:151], v[80:95]
    v_exp_f32 v141, v141
    v_exp_f32 v142, v142
    v_exp_f32 v143, v143
    v_cvt_pk_bf16_f32 v158, v140, v141
    v_cvt_pk_bf16_f32 v159, v142, v143
    v_mfma_f32_32x32x16_bf16 v[128:143], v[176:179], v[24:27], 0
    buffer_load_dwordx4 a[200:203], v248, s[40:43], s66 offen offset:3072
    v_exp_f32 v112, v112
    v_exp_f32 v113, v113
    v_exp_f32 v114, v114
    v_cvt_pk_bf16_f32 v144, v112, v113
    v_exp_f32 v115, v115
    v_mfma_f32_32x32x16_bf16 v[128:143], v[180:183], v[28:31], v[128:143]
    buffer_load_dwordx4 a[204:207], v248, s[40:43], s67 offen offset:3072
    v_exp_f32 v116, v116
    v_cvt_pk_bf16_f32 v145, v114, v115
    v_exp_f32 v117, v117
    v_exp_f32 v118, v118
    v_mfma_f32_32x32x16_bf16 a[16:31], a[104:107], a[100:103], a[16:31]
    v_cvt_pk_bf16_f32 v146, v116, v117
    v_exp_f32 v119, v119
    v_exp_f32 v120, v120
    v_cvt_pk_bf16_f32 v147, v118, v119
    v_exp_f32 v121, v121
    v_mfma_f32_32x32x16_bf16 v[96:111], v[168:171], v[152:155], v[96:111]
    v_exp_f32 v122, v122
    v_cvt_pk_bf16_f32 v148, v120, v121
    v_exp_f32 v123, v123
    v_exp_f32 v124, v124
    v_cvt_pk_bf16_f32 v149, v122, v123
    v_mfma_f32_32x32x16_bf16 v[96:111], v[172:175], v[156:159], v[96:111]
    v_exp_f32 v125, v125
    v_exp_f32 v126, v126
    v_exp_f32 v127, v127
    v_cvt_pk_bf16_f32 v150, v124, v125
    v_cvt_pk_bf16_f32 v151, v126, v127
    v_mfma_f32_32x32x16_bf16 v[112:127], v[176:179], v[32:35], 0
    buffer_load_dwordx4 v[160:163], v2, s[40:43], s58 offen offset:0
    v_exp_f32 v128, v128
    v_exp_f32 v129, v129
    v_exp_f32 v130, v130
    v_cvt_pk_bf16_f32 v152, v128, v129
    v_exp_f32 v131, v131
    v_mfma_f32_32x32x16_bf16 v[112:127], v[180:183], v[36:39], v[112:127]
    buffer_load_dwordx4 v[164:167], v2, s[40:43], s58 offen offset:1024
    v_exp_f32 v132, v132
    v_cvt_pk_bf16_f32 v153, v130, v131
    v_exp_f32 v133, v133
    v_exp_f32 v134, v134
    v_mfma_f32_32x32x16_bf16 a[32:47], a[108:111], a[96:99], a[32:47]
    buffer_load_dwordx4 v[168:171], v2, s[40:43], s58 offen offset:2048
    v_cvt_pk_bf16_f32 v154, v132, v133
    v_exp_f32 v135, v135
    v_exp_f32 v136, v136
    v_cvt_pk_bf16_f32 v155, v134, v135
    v_exp_f32 v137, v137
    v_mfma_f32_32x32x16_bf16 v[48:63], v[184:187], v[144:147], v[48:63]
    buffer_load_dwordx4 v[172:175], v2, s[40:43], s58 offen offset:3072
    v_exp_f32 v138, v138
    v_cvt_pk_bf16_f32 v156, v136, v137
    v_exp_f32 v139, v139
    v_exp_f32 v140, v140
    v_cvt_pk_bf16_f32 v157, v138, v139
    v_mfma_f32_32x32x16_bf16 v[48:63], v[188:191], v[148:151], v[48:63]
    v_exp_f32 v141, v141
    v_exp_f32 v142, v142
    v_exp_f32 v143, v143
    v_cvt_pk_bf16_f32 v158, v140, v141
    v_cvt_pk_bf16_f32 v159, v142, v143
    v_mfma_f32_32x32x16_bf16 v[128:143], v[176:179], v[40:43], 0
    buffer_load_dwordx4 a[208:211], v249, s[40:43], s64 offen offset:0
    v_exp_f32 v112, v112
    v_exp_f32 v113, v113
    v_exp_f32 v114, v114
    v_cvt_pk_bf16_f32 v144, v112, v113
    v_exp_f32 v115, v115
    v_mfma_f32_32x32x16_bf16 v[128:143], v[180:183], v[44:47], v[128:143]
    buffer_load_dwordx4 a[212:215], v249, s[40:43], s65 offen offset:0
    v_exp_f32 v116, v116
    v_cvt_pk_bf16_f32 v145, v114, v115
    v_exp_f32 v117, v117
    v_exp_f32 v118, v118
    v_mfma_f32_32x32x16_bf16 a[48:63], a[108:111], a[100:103], a[48:63]
    v_cvt_pk_bf16_f32 v146, v116, v117
    v_exp_f32 v119, v119
    v_exp_f32 v120, v120
    v_cvt_pk_bf16_f32 v147, v118, v119
    v_exp_f32 v121, v121
    v_mfma_f32_32x32x16_bf16 v[64:79], v[184:187], v[152:155], v[64:79]
    v_exp_f32 v122, v122
    v_cvt_pk_bf16_f32 v148, v120, v121
    v_exp_f32 v123, v123
    v_exp_f32 v124, v124
    v_cvt_pk_bf16_f32 v149, v122, v123
    v_mfma_f32_32x32x16_bf16 v[64:79], v[188:191], v[156:159], v[64:79]
    v_exp_f32 v125, v125
    v_exp_f32 v126, v126
    v_exp_f32 v127, v127
    v_cvt_pk_bf16_f32 v150, v124, v125
    v_cvt_pk_bf16_f32 v151, v126, v127
    s_waitcnt vmcnt(22)
    v_mfma_f32_32x32x16_bf16 v[112:127], v[192:195], v[16:19], 0
    buffer_load_dwordx4 a[216:219], v249, s[40:43], s66 offen offset:0
    v_exp_f32 v128, v128
    v_exp_f32 v129, v129
    v_exp_f32 v130, v130
    v_cvt_pk_bf16_f32 v152, v128, v129
    v_exp_f32 v131, v131
    v_mfma_f32_32x32x16_bf16 v[112:127], v[196:199], v[20:23], v[112:127]
    buffer_load_dwordx4 a[220:223], v249, s[40:43], s67 offen offset:0
    v_exp_f32 v132, v132
    v_cvt_pk_bf16_f32 v153, v130, v131
    v_exp_f32 v133, v133
    v_exp_f32 v134, v134
    v_mfma_f32_32x32x16_bf16 a[0:15], a[120:123], a[112:115], a[0:15]
    v_cvt_pk_bf16_f32 v154, v132, v133
    v_exp_f32 v135, v135
    v_exp_f32 v136, v136
    v_cvt_pk_bf16_f32 v155, v134, v135
    v_exp_f32 v137, v137
    v_mfma_f32_32x32x16_bf16 v[80:95], v[184:187], v[144:147], v[80:95]
    v_exp_f32 v138, v138
    v_cvt_pk_bf16_f32 v156, v136, v137
    v_exp_f32 v139, v139
    v_exp_f32 v140, v140
    v_cvt_pk_bf16_f32 v157, v138, v139
    v_mfma_f32_32x32x16_bf16 v[80:95], v[188:191], v[148:151], v[80:95]
    v_exp_f32 v141, v141
    v_exp_f32 v142, v142
    v_exp_f32 v143, v143
    v_cvt_pk_bf16_f32 v158, v140, v141
    v_cvt_pk_bf16_f32 v159, v142, v143
    v_mfma_f32_32x32x16_bf16 v[128:143], v[192:195], v[24:27], 0
    buffer_load_dwordx4 a[224:227], v249, s[40:43], s64 offen offset:1024
    v_exp_f32 v112, v112
    v_exp_f32 v113, v113
    v_exp_f32 v114, v114
    v_cvt_pk_bf16_f32 v144, v112, v113
    v_exp_f32 v115, v115
    v_mfma_f32_32x32x16_bf16 v[128:143], v[196:199], v[28:31], v[128:143]
    buffer_load_dwordx4 a[228:231], v249, s[40:43], s65 offen offset:1024
    v_exp_f32 v116, v116
    v_cvt_pk_bf16_f32 v145, v114, v115
    v_exp_f32 v117, v117
    v_exp_f32 v118, v118
    v_mfma_f32_32x32x16_bf16 a[16:31], a[120:123], a[116:119], a[16:31]
    v_cvt_pk_bf16_f32 v146, v116, v117
    v_exp_f32 v119, v119
    v_exp_f32 v120, v120
    v_cvt_pk_bf16_f32 v147, v118, v119
    v_exp_f32 v121, v121
    v_mfma_f32_32x32x16_bf16 v[96:111], v[184:187], v[152:155], v[96:111]
    v_exp_f32 v122, v122
    v_cvt_pk_bf16_f32 v148, v120, v121
    v_exp_f32 v123, v123
    v_exp_f32 v124, v124
    v_cvt_pk_bf16_f32 v149, v122, v123
    v_mfma_f32_32x32x16_bf16 v[96:111], v[188:191], v[156:159], v[96:111]
    v_exp_f32 v125, v125
    v_exp_f32 v126, v126
    v_exp_f32 v127, v127
    v_cvt_pk_bf16_f32 v150, v124, v125
    v_cvt_pk_bf16_f32 v151, v126, v127
    v_mfma_f32_32x32x16_bf16 v[112:127], v[192:195], v[32:35], 0
    buffer_load_dwordx4 v[176:179], v248, s[40:43], s58 offen offset:0
    v_exp_f32 v128, v128
    v_exp_f32 v129, v129
    v_exp_f32 v130, v130
    v_cvt_pk_bf16_f32 v152, v128, v129
    v_mfma_f32_32x32x16_bf16 a[32:47], a[124:127], a[112:115], a[32:47]
    buffer_load_dwordx4 v[180:183], v248, s[40:43], s58 offen offset:1024
    v_exp_f32 v131, v131
    v_exp_f32 v132, v132
    v_cvt_pk_bf16_f32 v153, v130, v131
    v_exp_f32 v133, v133
    v_mfma_f32_32x32x16_bf16 v[112:127], v[196:199], v[36:39], v[112:127]
    buffer_load_dwordx4 v[184:187], v248, s[40:43], s58 offen offset:2048
    v_exp_f32 v134, v134
    v_cvt_pk_bf16_f32 v154, v132, v133
    v_exp_f32 v135, v135
    v_exp_f32 v136, v136
    v_mfma_f32_32x32x16_bf16 v[48:63], v[200:203], v[144:147], v[48:63]
    buffer_load_dwordx4 v[188:191], v248, s[40:43], s58 offen offset:3072
    v_cvt_pk_bf16_f32 v155, v134, v135
    v_exp_f32 v137, v137
    v_exp_f32 v138, v138
    v_cvt_pk_bf16_f32 v156, v136, v137
    v_mfma_f32_32x32x16_bf16 a[48:63], a[124:127], a[116:119], a[48:63]
    v_exp_f32 v139, v139
    v_exp_f32 v140, v140
    v_cvt_pk_bf16_f32 v157, v138, v139
    v_exp_f32 v141, v141
    v_mfma_f32_32x32x16_bf16 v[48:63], v[204:207], v[148:151], v[48:63]
    v_exp_f32 v142, v142
    v_exp_f32 v143, v143
    v_cvt_pk_bf16_f32 v158, v140, v141
    v_cvt_pk_bf16_f32 v159, v142, v143
    v_mfma_f32_32x32x16_bf16 v[128:143], v[192:195], v[40:43], 0
    buffer_load_dwordx4 a[232:235], v249, s[40:43], s66 offen offset:1024
    v_exp_f32 v112, v112
    v_exp_f32 v113, v113
    v_exp_f32 v114, v114
    v_cvt_pk_bf16_f32 v144, v112, v113
    v_exp_f32 v115, v115
    v_mfma_f32_32x32x16_bf16 v[128:143], v[196:199], v[44:47], v[128:143]
    buffer_load_dwordx4 a[236:239], v249, s[40:43], s67 offen offset:1024
    v_exp_f32 v116, v116
    v_cvt_pk_bf16_f32 v145, v114, v115
    v_exp_f32 v117, v117
    v_exp_f32 v118, v118
    v_mfma_f32_32x32x16_bf16 a[0:15], a[136:139], a[128:131], a[0:15]
    v_cvt_pk_bf16_f32 v146, v116, v117
    v_exp_f32 v119, v119
    v_exp_f32 v120, v120
    v_cvt_pk_bf16_f32 v147, v118, v119
    v_exp_f32 v121, v121
    v_mfma_f32_32x32x16_bf16 v[64:79], v[200:203], v[152:155], v[64:79]
    v_exp_f32 v122, v122
    v_cvt_pk_bf16_f32 v148, v120, v121
    v_exp_f32 v123, v123
    v_exp_f32 v124, v124
    v_cvt_pk_bf16_f32 v149, v122, v123
    v_mfma_f32_32x32x16_bf16 v[64:79], v[204:207], v[156:159], v[64:79]
    v_exp_f32 v125, v125
    v_exp_f32 v126, v126
    v_exp_f32 v127, v127
    v_cvt_pk_bf16_f32 v150, v124, v125
    v_cvt_pk_bf16_f32 v151, v126, v127
    s_waitcnt vmcnt(22)
    v_mfma_f32_32x32x16_bf16 v[112:127], v[208:211], v[16:19], 0
    buffer_load_dwordx4 a[240:243], v249, s[40:43], s64 offen offset:2048
    v_exp_f32 v128, v128
    v_exp_f32 v129, v129
    v_exp_f32 v130, v130
    v_cvt_pk_bf16_f32 v152, v128, v129
    v_exp_f32 v131, v131
    v_mfma_f32_32x32x16_bf16 v[112:127], v[212:215], v[20:23], v[112:127]
    buffer_load_dwordx4 a[244:247], v249, s[40:43], s65 offen offset:2048
    v_exp_f32 v132, v132
    v_cvt_pk_bf16_f32 v153, v130, v131
    v_exp_f32 v133, v133
    v_exp_f32 v134, v134
    v_mfma_f32_32x32x16_bf16 a[16:31], a[136:139], a[132:135], a[16:31]
    v_cvt_pk_bf16_f32 v154, v132, v133
    v_exp_f32 v135, v135
    v_exp_f32 v136, v136
    v_cvt_pk_bf16_f32 v155, v134, v135
    v_exp_f32 v137, v137
    v_mfma_f32_32x32x16_bf16 v[80:95], v[200:203], v[144:147], v[80:95]
    v_exp_f32 v138, v138
    v_cvt_pk_bf16_f32 v156, v136, v137
    v_exp_f32 v139, v139
    v_exp_f32 v140, v140
    v_cvt_pk_bf16_f32 v157, v138, v139
    v_mfma_f32_32x32x16_bf16 v[80:95], v[204:207], v[148:151], v[80:95]
    v_exp_f32 v141, v141
    v_exp_f32 v142, v142
    v_exp_f32 v143, v143
    v_cvt_pk_bf16_f32 v158, v140, v141
    v_cvt_pk_bf16_f32 v159, v142, v143
    v_mfma_f32_32x32x16_bf16 v[128:143], v[208:211], v[24:27], 0
    buffer_load_dwordx4 a[248:251], v249, s[40:43], s66 offen offset:2048
    v_exp_f32 v112, v112
    v_exp_f32 v113, v113
    v_exp_f32 v114, v114
    v_cvt_pk_bf16_f32 v144, v112, v113
    v_exp_f32 v115, v115
    v_mfma_f32_32x32x16_bf16 v[128:143], v[212:215], v[28:31], v[128:143]
    buffer_load_dwordx4 a[252:255], v249, s[40:43], s67 offen offset:2048
    v_exp_f32 v116, v116
    v_cvt_pk_bf16_f32 v145, v114, v115
    v_exp_f32 v117, v117
    v_exp_f32 v118, v118
    v_mfma_f32_32x32x16_bf16 a[32:47], a[140:143], a[128:131], a[32:47]
    v_cvt_pk_bf16_f32 v146, v116, v117
    v_exp_f32 v119, v119
    v_exp_f32 v120, v120
    v_cvt_pk_bf16_f32 v147, v118, v119
    v_exp_f32 v121, v121
    v_mfma_f32_32x32x16_bf16 v[96:111], v[200:203], v[152:155], v[96:111]
    v_exp_f32 v122, v122
    v_cvt_pk_bf16_f32 v148, v120, v121
    v_exp_f32 v123, v123
    v_exp_f32 v124, v124
    v_cvt_pk_bf16_f32 v149, v122, v123
    v_mfma_f32_32x32x16_bf16 v[96:111], v[204:207], v[156:159], v[96:111]
    v_exp_f32 v125, v125
    v_exp_f32 v126, v126
    v_exp_f32 v127, v127
    v_cvt_pk_bf16_f32 v150, v124, v125
    v_cvt_pk_bf16_f32 v151, v126, v127
    v_mfma_f32_32x32x16_bf16 v[112:127], v[208:211], v[32:35], 0
    buffer_load_dwordx4 v[192:195], v249, s[40:43], s58 offen offset:0
    v_exp_f32 v128, v128
    v_exp_f32 v129, v129
    v_exp_f32 v130, v130
    v_cvt_pk_bf16_f32 v152, v128, v129
    v_exp_f32 v131, v131
    v_mfma_f32_32x32x16_bf16 v[112:127], v[212:215], v[36:39], v[112:127]
    buffer_load_dwordx4 v[196:199], v249, s[40:43], s58 offen offset:1024
    v_exp_f32 v132, v132
    v_cvt_pk_bf16_f32 v153, v130, v131
    v_exp_f32 v133, v133
    v_exp_f32 v134, v134
    v_mfma_f32_32x32x16_bf16 a[48:63], a[140:143], a[132:135], a[48:63]
    buffer_load_dwordx4 v[200:203], v249, s[40:43], s58 offen offset:2048
    v_cvt_pk_bf16_f32 v154, v132, v133
    v_exp_f32 v135, v135
    v_exp_f32 v136, v136
    v_cvt_pk_bf16_f32 v155, v134, v135
    v_exp_f32 v137, v137
    v_mfma_f32_32x32x16_bf16 v[48:63], v[216:219], v[144:147], v[48:63]
    buffer_load_dwordx4 v[204:207], v249, s[40:43], s58 offen offset:3072
    v_exp_f32 v138, v138
    v_cvt_pk_bf16_f32 v156, v136, v137
    v_exp_f32 v139, v139
    v_exp_f32 v140, v140
    v_cvt_pk_bf16_f32 v157, v138, v139
    v_mfma_f32_32x32x16_bf16 v[48:63], v[220:223], v[148:151], v[48:63]
    v_exp_f32 v141, v141
    v_exp_f32 v142, v142
    v_exp_f32 v143, v143
    v_cvt_pk_bf16_f32 v158, v140, v141
    v_cvt_pk_bf16_f32 v159, v142, v143
    v_mfma_f32_32x32x16_bf16 v[128:143], v[208:211], v[40:43], 0
    buffer_load_dwordx4 v[224:227], v249, s[40:43], s64 offen offset:3072
    v_exp_f32 v112, v112
    v_exp_f32 v113, v113
    v_exp_f32 v114, v114
    v_cvt_pk_bf16_f32 v144, v112, v113
    v_exp_f32 v115, v115
    v_mfma_f32_32x32x16_bf16 v[128:143], v[212:215], v[44:47], v[128:143]
    buffer_load_dwordx4 v[228:231], v249, s[40:43], s65 offen offset:3072
    v_exp_f32 v116, v116
    v_cvt_pk_bf16_f32 v145, v114, v115
    v_exp_f32 v117, v117
    v_exp_f32 v118, v118
    v_mfma_f32_32x32x16_bf16 a[0:15], a[152:155], a[144:147], a[0:15]
    v_cvt_pk_bf16_f32 v146, v116, v117
    v_exp_f32 v119, v119
    v_exp_f32 v120, v120
    v_cvt_pk_bf16_f32 v147, v118, v119
    v_exp_f32 v121, v121
    v_mfma_f32_32x32x16_bf16 v[64:79], v[216:219], v[152:155], v[64:79]
    v_exp_f32 v122, v122
    v_cvt_pk_bf16_f32 v148, v120, v121
    v_exp_f32 v123, v123
    v_exp_f32 v124, v124
    v_cvt_pk_bf16_f32 v149, v122, v123
    v_mfma_f32_32x32x16_bf16 v[64:79], v[220:223], v[156:159], v[64:79]
    v_exp_f32 v125, v125
    v_exp_f32 v126, v126
    v_exp_f32 v127, v127
    v_cvt_pk_bf16_f32 v150, v124, v125
    v_cvt_pk_bf16_f32 v151, v126, v127
    s_waitcnt vmcnt(22)
    v_mfma_f32_32x32x16_bf16 v[112:127], v[160:163], v[16:19], 0
    buffer_load_dwordx4 v[232:235], v249, s[40:43], s66 offen offset:3072
    v_exp_f32 v128, v128
    v_exp_f32 v129, v129
    v_exp_f32 v130, v130
    v_cvt_pk_bf16_f32 v152, v128, v129
    v_exp_f32 v131, v131
    v_mfma_f32_32x32x16_bf16 v[112:127], v[164:167], v[20:23], v[112:127]
    buffer_load_dwordx4 v[236:239], v249, s[40:43], s67 offen offset:3072
    v_exp_f32 v132, v132
    v_cvt_pk_bf16_f32 v153, v130, v131
    v_exp_f32 v133, v133
    v_exp_f32 v134, v134
    v_mfma_f32_32x32x16_bf16 a[16:31], a[152:155], a[148:151], a[16:31]
    v_cvt_pk_bf16_f32 v154, v132, v133
    v_exp_f32 v135, v135
    v_exp_f32 v136, v136
    v_cvt_pk_bf16_f32 v155, v134, v135
    v_exp_f32 v137, v137
    v_mfma_f32_32x32x16_bf16 v[80:95], v[216:219], v[144:147], v[80:95]
    v_exp_f32 v138, v138
    v_cvt_pk_bf16_f32 v156, v136, v137
    v_exp_f32 v139, v139
    v_exp_f32 v140, v140
    v_cvt_pk_bf16_f32 v157, v138, v139
    v_mfma_f32_32x32x16_bf16 v[80:95], v[220:223], v[148:151], v[80:95]
    v_exp_f32 v141, v141
    v_exp_f32 v142, v142
    v_exp_f32 v143, v143
    v_cvt_pk_bf16_f32 v158, v140, v141
    v_cvt_pk_bf16_f32 v159, v142, v143
    v_mfma_f32_32x32x16_bf16 v[128:143], v[160:163], v[24:27], 0
    buffer_load_dwordx4 a[64:67], v250, s[40:43], s64 offen offset:0
    v_exp_f32 v112, v112
    v_exp_f32 v113, v113
    v_exp_f32 v114, v114
    v_cvt_pk_bf16_f32 v144, v112, v113
    v_exp_f32 v115, v115
    v_mfma_f32_32x32x16_bf16 v[128:143], v[164:167], v[28:31], v[128:143]
    buffer_load_dwordx4 a[68:71], v250, s[40:43], s65 offen offset:0
    v_exp_f32 v116, v116
    v_cvt_pk_bf16_f32 v145, v114, v115
    v_exp_f32 v117, v117
    v_exp_f32 v118, v118
    v_mfma_f32_32x32x16_bf16 a[32:47], a[156:159], a[144:147], a[32:47]
    v_cvt_pk_bf16_f32 v146, v116, v117
    v_exp_f32 v119, v119
    v_exp_f32 v120, v120
    v_cvt_pk_bf16_f32 v147, v118, v119
    v_exp_f32 v121, v121
    v_mfma_f32_32x32x16_bf16 v[96:111], v[216:219], v[152:155], v[96:111]
    v_exp_f32 v122, v122
    v_cvt_pk_bf16_f32 v148, v120, v121
    v_exp_f32 v123, v123
    v_exp_f32 v124, v124
    v_cvt_pk_bf16_f32 v149, v122, v123
    v_mfma_f32_32x32x16_bf16 v[96:111], v[220:223], v[156:159], v[96:111]
    v_exp_f32 v125, v125
    v_exp_f32 v126, v126
    v_exp_f32 v127, v127
    v_cvt_pk_bf16_f32 v150, v124, v125
    v_cvt_pk_bf16_f32 v151, v126, v127
    v_mfma_f32_32x32x16_bf16 v[112:127], v[160:163], v[32:35], 0
    buffer_load_dwordx4 v[208:211], v250, s[40:43], s58 offen offset:0
    v_exp_f32 v128, v128
    v_exp_f32 v129, v129
    v_exp_f32 v130, v130
    v_cvt_pk_bf16_f32 v152, v128, v129
    v_exp_f32 v131, v131
    v_mfma_f32_32x32x16_bf16 v[112:127], v[164:167], v[36:39], v[112:127]
    buffer_load_dwordx4 v[212:215], v250, s[40:43], s58 offen offset:1024
    v_exp_f32 v132, v132
    v_cvt_pk_bf16_f32 v153, v130, v131
    v_exp_f32 v133, v133
    v_exp_f32 v134, v134
    v_mfma_f32_32x32x16_bf16 a[48:63], a[156:159], a[148:151], a[48:63]
    buffer_load_dwordx4 v[216:219], v250, s[40:43], s58 offen offset:2048
    v_cvt_pk_bf16_f32 v154, v132, v133
    v_exp_f32 v135, v135
    v_exp_f32 v136, v136
    v_cvt_pk_bf16_f32 v155, v134, v135
    v_exp_f32 v137, v137
    v_mfma_f32_32x32x16_bf16 v[48:63], v[168:171], v[144:147], v[48:63]
    buffer_load_dwordx4 v[220:223], v250, s[40:43], s58 offen offset:3072
    v_exp_f32 v138, v138
    v_cvt_pk_bf16_f32 v156, v136, v137
    v_exp_f32 v139, v139
    v_exp_f32 v140, v140
    v_cvt_pk_bf16_f32 v157, v138, v139
    v_mfma_f32_32x32x16_bf16 v[48:63], v[172:175], v[148:151], v[48:63]
    v_exp_f32 v141, v141
    v_exp_f32 v142, v142
    v_exp_f32 v143, v143
    v_cvt_pk_bf16_f32 v158, v140, v141
    v_cvt_pk_bf16_f32 v159, v142, v143
    v_mfma_f32_32x32x16_bf16 v[128:143], v[160:163], v[40:43], 0
    buffer_load_dwordx4 a[72:75], v250, s[40:43], s66 offen offset:0
    v_exp_f32 v112, v112
    v_exp_f32 v113, v113
    v_exp_f32 v114, v114
    v_cvt_pk_bf16_f32 v144, v112, v113
    v_exp_f32 v115, v115
    v_mfma_f32_32x32x16_bf16 v[128:143], v[164:167], v[44:47], v[128:143]
    buffer_load_dwordx4 a[76:79], v250, s[40:43], s67 offen offset:0
    v_exp_f32 v116, v116
    v_cvt_pk_bf16_f32 v145, v114, v115
    v_exp_f32 v117, v117
    v_exp_f32 v118, v118
    v_mfma_f32_32x32x16_bf16 a[0:15], a[168:171], a[160:163], a[0:15]
    v_cvt_pk_bf16_f32 v146, v116, v117
    v_exp_f32 v119, v119
    v_exp_f32 v120, v120
    v_cvt_pk_bf16_f32 v147, v118, v119
    v_exp_f32 v121, v121
    v_mfma_f32_32x32x16_bf16 v[64:79], v[168:171], v[152:155], v[64:79]
    v_exp_f32 v122, v122
    v_cvt_pk_bf16_f32 v148, v120, v121
    v_exp_f32 v123, v123
    v_exp_f32 v124, v124
    v_cvt_pk_bf16_f32 v149, v122, v123
    v_mfma_f32_32x32x16_bf16 v[64:79], v[172:175], v[156:159], v[64:79]
    v_exp_f32 v125, v125
    v_exp_f32 v126, v126
    v_exp_f32 v127, v127
    v_cvt_pk_bf16_f32 v150, v124, v125
    v_cvt_pk_bf16_f32 v151, v126, v127
    s_waitcnt vmcnt(22)
    v_mfma_f32_32x32x16_bf16 v[112:127], v[176:179], v[16:19], 0
    buffer_load_dwordx4 a[80:83], v250, s[40:43], s64 offen offset:1024
    v_exp_f32 v128, v128
    v_exp_f32 v129, v129
    v_exp_f32 v130, v130
    v_cvt_pk_bf16_f32 v152, v128, v129
    v_exp_f32 v131, v131
    v_mfma_f32_32x32x16_bf16 v[112:127], v[180:183], v[20:23], v[112:127]
    buffer_load_dwordx4 a[84:87], v250, s[40:43], s65 offen offset:1024
    v_exp_f32 v132, v132
    v_cvt_pk_bf16_f32 v153, v130, v131
    v_exp_f32 v133, v133
    v_exp_f32 v134, v134
    v_mfma_f32_32x32x16_bf16 a[16:31], a[168:171], a[164:167], a[16:31]
    v_cvt_pk_bf16_f32 v154, v132, v133
    v_exp_f32 v135, v135
    v_exp_f32 v136, v136
    v_cvt_pk_bf16_f32 v155, v134, v135
    v_exp_f32 v137, v137
    v_mfma_f32_32x32x16_bf16 v[80:95], v[168:171], v[144:147], v[80:95]
    v_exp_f32 v138, v138
    v_cvt_pk_bf16_f32 v156, v136, v137
    v_exp_f32 v139, v139
    v_exp_f32 v140, v140
    v_cvt_pk_bf16_f32 v157, v138, v139
    v_mfma_f32_32x32x16_bf16 v[80:95], v[172:175], v[148:151], v[80:95]
    v_exp_f32 v141, v141
    v_exp_f32 v142, v142
    v_exp_f32 v143, v143
    v_cvt_pk_bf16_f32 v158, v140, v141
    v_cvt_pk_bf16_f32 v159, v142, v143
    v_mfma_f32_32x32x16_bf16 v[128:143], v[176:179], v[24:27], 0
    buffer_load_dwordx4 a[88:91], v250, s[40:43], s66 offen offset:1024
    v_exp_f32 v112, v112
    v_exp_f32 v113, v113
    v_exp_f32 v114, v114
    v_cvt_pk_bf16_f32 v144, v112, v113
    v_exp_f32 v115, v115
    v_mfma_f32_32x32x16_bf16 v[128:143], v[180:183], v[28:31], v[128:143]
    buffer_load_dwordx4 a[92:95], v250, s[40:43], s67 offen offset:1024
    v_exp_f32 v116, v116
    v_cvt_pk_bf16_f32 v145, v114, v115
    v_exp_f32 v117, v117
    v_exp_f32 v118, v118
    v_mfma_f32_32x32x16_bf16 a[32:47], a[172:175], a[160:163], a[32:47]
    v_cvt_pk_bf16_f32 v146, v116, v117
    v_exp_f32 v119, v119
    v_exp_f32 v120, v120
    v_cvt_pk_bf16_f32 v147, v118, v119
    v_exp_f32 v121, v121
    v_mfma_f32_32x32x16_bf16 v[96:111], v[168:171], v[152:155], v[96:111]
    v_exp_f32 v122, v122
    v_cvt_pk_bf16_f32 v148, v120, v121
    v_exp_f32 v123, v123
    v_exp_f32 v124, v124
    v_cvt_pk_bf16_f32 v149, v122, v123
    v_mfma_f32_32x32x16_bf16 v[96:111], v[172:175], v[156:159], v[96:111]
    v_exp_f32 v125, v125
    v_exp_f32 v126, v126
    v_exp_f32 v127, v127
    v_cvt_pk_bf16_f32 v150, v124, v125
    v_cvt_pk_bf16_f32 v151, v126, v127
    v_mfma_f32_32x32x16_bf16 v[112:127], v[176:179], v[32:35], 0
    buffer_load_dwordx4 v[160:163], v2, s[40:43], s59 offen offset:0
    v_exp_f32 v128, v128
    v_exp_f32 v129, v129
    v_exp_f32 v130, v130
    v_cvt_pk_bf16_f32 v152, v128, v129
    v_exp_f32 v131, v131
    v_mfma_f32_32x32x16_bf16 v[112:127], v[180:183], v[36:39], v[112:127]
    buffer_load_dwordx4 v[164:167], v2, s[40:43], s59 offen offset:1024
    v_exp_f32 v132, v132
    v_cvt_pk_bf16_f32 v153, v130, v131
    v_exp_f32 v133, v133
    v_exp_f32 v134, v134
    v_mfma_f32_32x32x16_bf16 a[48:63], a[172:175], a[164:167], a[48:63]
    buffer_load_dwordx4 v[168:171], v2, s[40:43], s59 offen offset:2048
    v_cvt_pk_bf16_f32 v154, v132, v133
    v_exp_f32 v135, v135
    v_exp_f32 v136, v136
    v_cvt_pk_bf16_f32 v155, v134, v135
    v_exp_f32 v137, v137
    v_mfma_f32_32x32x16_bf16 v[48:63], v[184:187], v[144:147], v[48:63]
    buffer_load_dwordx4 v[172:175], v2, s[40:43], s59 offen offset:3072
    v_exp_f32 v138, v138
    v_cvt_pk_bf16_f32 v156, v136, v137
    v_exp_f32 v139, v139
    v_exp_f32 v140, v140
    v_cvt_pk_bf16_f32 v157, v138, v139
    v_mfma_f32_32x32x16_bf16 v[48:63], v[188:191], v[148:151], v[48:63]
    v_exp_f32 v141, v141
    v_exp_f32 v142, v142
    v_exp_f32 v143, v143
    v_cvt_pk_bf16_f32 v158, v140, v141
    v_cvt_pk_bf16_f32 v159, v142, v143
    v_mfma_f32_32x32x16_bf16 v[128:143], v[176:179], v[40:43], 0
    buffer_load_dwordx4 a[96:99], v250, s[40:43], s64 offen offset:2048
    v_exp_f32 v112, v112
    v_exp_f32 v113, v113
    v_exp_f32 v114, v114
    v_cvt_pk_bf16_f32 v144, v112, v113
    v_mfma_f32_32x32x16_bf16 a[0:15], a[200:203], a[192:195], a[0:15]
    buffer_load_dwordx4 a[100:103], v250, s[40:43], s65 offen offset:2048
    v_exp_f32 v115, v115
    v_exp_f32 v116, v116
    v_cvt_pk_bf16_f32 v145, v114, v115
    v_exp_f32 v117, v117
    v_mfma_f32_32x32x16_bf16 v[128:143], v[180:183], v[44:47], v[128:143]
    v_exp_f32 v118, v118
    v_cvt_pk_bf16_f32 v146, v116, v117
    v_exp_f32 v119, v119
    v_exp_f32 v120, v120
    v_mfma_f32_32x32x16_bf16 v[64:79], v[184:187], v[152:155], v[64:79]
    v_cvt_pk_bf16_f32 v147, v118, v119
    v_exp_f32 v121, v121
    v_exp_f32 v122, v122
    v_cvt_pk_bf16_f32 v148, v120, v121
    v_mfma_f32_32x32x16_bf16 a[16:31], a[200:203], a[196:199], a[16:31]
    v_exp_f32 v123, v123
    v_exp_f32 v124, v124
    v_cvt_pk_bf16_f32 v149, v122, v123
    v_exp_f32 v125, v125
    v_mfma_f32_32x32x16_bf16 v[64:79], v[188:191], v[156:159], v[64:79]
    v_exp_f32 v126, v126
    v_exp_f32 v127, v127
    v_cvt_pk_bf16_f32 v150, v124, v125
    v_cvt_pk_bf16_f32 v151, v126, v127
    s_waitcnt vmcnt(22)
    v_mfma_f32_32x32x16_bf16 v[112:127], v[192:195], v[16:19], 0
    buffer_load_dwordx4 a[104:107], v250, s[40:43], s66 offen offset:2048
    v_exp_f32 v128, v128
    v_exp_f32 v129, v129
    v_exp_f32 v130, v130
    v_cvt_pk_bf16_f32 v152, v128, v129
    v_exp_f32 v131, v131
    v_mfma_f32_32x32x16_bf16 v[112:127], v[196:199], v[20:23], v[112:127]
    buffer_load_dwordx4 a[108:111], v250, s[40:43], s67 offen offset:2048
    v_exp_f32 v132, v132
    v_cvt_pk_bf16_f32 v153, v130, v131
    v_exp_f32 v133, v133
    v_exp_f32 v134, v134
    v_mfma_f32_32x32x16_bf16 a[32:47], a[204:207], a[192:195], a[32:47]
    v_cvt_pk_bf16_f32 v154, v132, v133
    v_exp_f32 v135, v135
    v_exp_f32 v136, v136
    v_cvt_pk_bf16_f32 v155, v134, v135
    v_exp_f32 v137, v137
    v_mfma_f32_32x32x16_bf16 v[80:95], v[184:187], v[144:147], v[80:95]
    v_exp_f32 v138, v138
    v_cvt_pk_bf16_f32 v156, v136, v137
    v_exp_f32 v139, v139
    v_exp_f32 v140, v140
    v_cvt_pk_bf16_f32 v157, v138, v139
    v_mfma_f32_32x32x16_bf16 v[80:95], v[188:191], v[148:151], v[80:95]
    v_exp_f32 v141, v141
    v_exp_f32 v142, v142
    v_exp_f32 v143, v143
    v_cvt_pk_bf16_f32 v158, v140, v141
    v_cvt_pk_bf16_f32 v159, v142, v143
    v_mfma_f32_32x32x16_bf16 v[128:143], v[192:195], v[24:27], 0
    buffer_load_dwordx4 a[112:115], v250, s[40:43], s64 offen offset:3072
    v_exp_f32 v112, v112
    v_exp_f32 v113, v113
    v_exp_f32 v114, v114
    v_cvt_pk_bf16_f32 v144, v112, v113
    v_exp_f32 v115, v115
    v_mfma_f32_32x32x16_bf16 v[128:143], v[196:199], v[28:31], v[128:143]
    buffer_load_dwordx4 a[116:119], v250, s[40:43], s65 offen offset:3072
    v_exp_f32 v116, v116
    v_cvt_pk_bf16_f32 v145, v114, v115
    v_exp_f32 v117, v117
    v_exp_f32 v118, v118
    v_mfma_f32_32x32x16_bf16 a[48:63], a[204:207], a[196:199], a[48:63]
    v_cvt_pk_bf16_f32 v146, v116, v117
    v_exp_f32 v119, v119
    v_exp_f32 v120, v120
    v_cvt_pk_bf16_f32 v147, v118, v119
    v_exp_f32 v121, v121
    v_mfma_f32_32x32x16_bf16 v[96:111], v[184:187], v[152:155], v[96:111]
    v_exp_f32 v122, v122
    v_cvt_pk_bf16_f32 v148, v120, v121
    v_exp_f32 v123, v123
    v_exp_f32 v124, v124
    v_cvt_pk_bf16_f32 v149, v122, v123
    v_mfma_f32_32x32x16_bf16 v[96:111], v[188:191], v[156:159], v[96:111]
    v_exp_f32 v125, v125
    v_exp_f32 v126, v126
    v_exp_f32 v127, v127
    v_cvt_pk_bf16_f32 v150, v124, v125
    v_cvt_pk_bf16_f32 v151, v126, v127
    v_mfma_f32_32x32x16_bf16 v[112:127], v[192:195], v[32:35], 0
    buffer_load_dwordx4 v[176:179], v248, s[40:43], s59 offen offset:0
    v_exp_f32 v128, v128
    v_exp_f32 v129, v129
    v_exp_f32 v130, v130
    v_cvt_pk_bf16_f32 v152, v128, v129
    v_exp_f32 v131, v131
    v_mfma_f32_32x32x16_bf16 v[112:127], v[196:199], v[36:39], v[112:127]
    buffer_load_dwordx4 v[180:183], v248, s[40:43], s59 offen offset:1024
    v_exp_f32 v132, v132
    v_cvt_pk_bf16_f32 v153, v130, v131
    v_exp_f32 v133, v133
    v_exp_f32 v134, v134
    v_mfma_f32_32x32x16_bf16 a[0:15], a[216:219], a[208:211], a[0:15]
    buffer_load_dwordx4 v[184:187], v248, s[40:43], s59 offen offset:2048
    v_cvt_pk_bf16_f32 v154, v132, v133
    v_exp_f32 v135, v135
    v_exp_f32 v136, v136
    v_cvt_pk_bf16_f32 v155, v134, v135
    v_exp_f32 v137, v137
    v_mfma_f32_32x32x16_bf16 v[48:63], v[200:203], v[144:147], v[48:63]
    buffer_load_dwordx4 v[188:191], v248, s[40:43], s59 offen offset:3072
    v_exp_f32 v138, v138
    v_cvt_pk_bf16_f32 v156, v136, v137
    v_exp_f32 v139, v139
    v_exp_f32 v140, v140
    v_cvt_pk_bf16_f32 v157, v138, v139
    v_mfma_f32_32x32x16_bf16 v[48:63], v[204:207], v[148:151], v[48:63]
    v_exp_f32 v141, v141
    v_exp_f32 v142, v142
    v_exp_f32 v143, v143
    v_cvt_pk_bf16_f32 v158, v140, v141
    v_cvt_pk_bf16_f32 v159, v142, v143
    v_mfma_f32_32x32x16_bf16 v[128:143], v[192:195], v[40:43], 0
    buffer_load_dwordx4 v[240:243], v7, s[28:31], s74 offen offset:0
    v_exp_f32 v112, v112
    v_exp_f32 v113, v113
    v_exp_f32 v114, v114
    v_cvt_pk_bf16_f32 v144, v112, v113
    v_exp_f32 v115, v115
    v_mfma_f32_32x32x16_bf16 v[128:143], v[196:199], v[44:47], v[128:143]
    buffer_load_dwordx4 v[244:247], v7, s[28:31], s74 offen offset:32
    v_exp_f32 v116, v116
    v_cvt_pk_bf16_f32 v145, v114, v115
    v_exp_f32 v117, v117
    v_exp_f32 v118, v118
    v_mfma_f32_32x32x16_bf16 a[16:31], a[216:219], a[212:215], a[16:31]
    v_cvt_pk_bf16_f32 v146, v116, v117
    v_exp_f32 v119, v119
    v_exp_f32 v120, v120
    v_cvt_pk_bf16_f32 v147, v118, v119
    v_exp_f32 v121, v121
    v_mfma_f32_32x32x16_bf16 v[64:79], v[200:203], v[152:155], v[64:79]
    v_exp_f32 v122, v122
    v_cvt_pk_bf16_f32 v148, v120, v121
    v_exp_f32 v123, v123
    v_exp_f32 v124, v124
    v_cvt_pk_bf16_f32 v149, v122, v123
    v_mfma_f32_32x32x16_bf16 v[64:79], v[204:207], v[156:159], v[64:79]
    v_exp_f32 v125, v125
    v_exp_f32 v126, v126
    v_exp_f32 v127, v127
    v_cvt_pk_bf16_f32 v150, v124, v125
    v_cvt_pk_bf16_f32 v151, v126, v127
    s_waitcnt vmcnt(22)
    v_mfma_f32_32x32x16_bf16 v[112:127], v[208:211], v[16:19], 0
    buffer_load_dwordx4 a[120:123], v250, s[40:43], s66 offen offset:3072
    v_exp_f32 v128, v128
    v_exp_f32 v129, v129
    v_exp_f32 v130, v130
    v_cvt_pk_bf16_f32 v152, v128, v129
    v_exp_f32 v131, v131
    v_mfma_f32_32x32x16_bf16 v[112:127], v[212:215], v[20:23], v[112:127]
    buffer_load_dwordx4 a[124:127], v250, s[40:43], s67 offen offset:3072
    v_exp_f32 v132, v132
    v_cvt_pk_bf16_f32 v153, v130, v131
    v_exp_f32 v133, v133
    v_exp_f32 v134, v134
    v_mfma_f32_32x32x16_bf16 a[32:47], a[220:223], a[208:211], a[32:47]
    v_cvt_pk_bf16_f32 v154, v132, v133
    v_exp_f32 v135, v135
    v_exp_f32 v136, v136
    v_cvt_pk_bf16_f32 v155, v134, v135
    v_exp_f32 v137, v137
    v_mfma_f32_32x32x16_bf16 v[80:95], v[200:203], v[144:147], v[80:95]
    v_exp_f32 v138, v138
    v_cvt_pk_bf16_f32 v156, v136, v137
    v_exp_f32 v139, v139
    v_exp_f32 v140, v140
    v_cvt_pk_bf16_f32 v157, v138, v139
    v_mfma_f32_32x32x16_bf16 v[80:95], v[204:207], v[148:151], v[80:95]
    v_exp_f32 v141, v141
    v_exp_f32 v142, v142
    v_exp_f32 v143, v143
    v_cvt_pk_bf16_f32 v158, v140, v141
    v_cvt_pk_bf16_f32 v159, v142, v143
    v_mfma_f32_32x32x16_bf16 v[128:143], v[208:211], v[24:27], 0
    buffer_load_dwordx4 a[128:131], v2, s[40:43], s68 offen offset:0
    v_exp_f32 v112, v112
    v_exp_f32 v113, v113
    v_exp_f32 v114, v114
    v_cvt_pk_bf16_f32 v144, v112, v113
    v_exp_f32 v115, v115
    v_mfma_f32_32x32x16_bf16 v[128:143], v[212:215], v[28:31], v[128:143]
    buffer_load_dwordx4 a[132:135], v2, s[40:43], s69 offen offset:0
    v_exp_f32 v116, v116
    v_cvt_pk_bf16_f32 v145, v114, v115
    v_exp_f32 v117, v117
    v_exp_f32 v118, v118
    v_mfma_f32_32x32x16_bf16 a[48:63], a[220:223], a[212:215], a[48:63]
    v_cvt_pk_bf16_f32 v146, v116, v117
    v_exp_f32 v119, v119
    v_exp_f32 v120, v120
    v_cvt_pk_bf16_f32 v147, v118, v119
    v_exp_f32 v121, v121
    v_mfma_f32_32x32x16_bf16 v[96:111], v[200:203], v[152:155], v[96:111]
    v_exp_f32 v122, v122
    v_cvt_pk_bf16_f32 v148, v120, v121
    v_exp_f32 v123, v123
    v_exp_f32 v124, v124
    v_cvt_pk_bf16_f32 v149, v122, v123
    v_mfma_f32_32x32x16_bf16 v[96:111], v[204:207], v[156:159], v[96:111]
    v_exp_f32 v125, v125
    v_exp_f32 v126, v126
    v_exp_f32 v127, v127
    v_cvt_pk_bf16_f32 v150, v124, v125
    v_cvt_pk_bf16_f32 v151, v126, v127
    v_mfma_f32_32x32x16_bf16 v[112:127], v[208:211], v[32:35], 0
    buffer_load_dwordx4 v[192:195], v249, s[40:43], s59 offen offset:0
    v_exp_f32 v128, v128
    v_exp_f32 v129, v129
    v_exp_f32 v130, v130
    v_cvt_pk_bf16_f32 v152, v128, v129
    v_exp_f32 v131, v131
    v_mfma_f32_32x32x16_bf16 v[112:127], v[212:215], v[36:39], v[112:127]
    buffer_load_dwordx4 v[196:199], v249, s[40:43], s59 offen offset:1024
    v_exp_f32 v132, v132
    v_cvt_pk_bf16_f32 v153, v130, v131
    v_exp_f32 v133, v133
    v_exp_f32 v134, v134
    v_mfma_f32_32x32x16_bf16 a[0:15], a[232:235], a[224:227], a[0:15]
    buffer_load_dwordx4 v[200:203], v249, s[40:43], s59 offen offset:2048
    v_cvt_pk_bf16_f32 v154, v132, v133
    v_exp_f32 v135, v135
    v_exp_f32 v136, v136
    v_cvt_pk_bf16_f32 v155, v134, v135
    v_exp_f32 v137, v137
    v_mfma_f32_32x32x16_bf16 v[48:63], v[216:219], v[144:147], v[48:63]
    buffer_load_dwordx4 v[204:207], v249, s[40:43], s59 offen offset:3072
    v_exp_f32 v138, v138
    v_cvt_pk_bf16_f32 v156, v136, v137
    v_exp_f32 v139, v139
    v_exp_f32 v140, v140
    v_cvt_pk_bf16_f32 v157, v138, v139
    v_mfma_f32_32x32x16_bf16 v[48:63], v[220:223], v[148:151], v[48:63]
    v_exp_f32 v141, v141
    v_exp_f32 v142, v142
    v_exp_f32 v143, v143
    v_cvt_pk_bf16_f32 v158, v140, v141
    v_cvt_pk_bf16_f32 v159, v142, v143
    v_mfma_f32_32x32x16_bf16 v[128:143], v[208:211], v[40:43], 0
    buffer_load_dwordx4 a[136:139], v2, s[40:43], s70 offen offset:0
    v_exp_f32 v112, v112
    v_exp_f32 v113, v113
    v_exp_f32 v114, v114
    v_cvt_pk_bf16_f32 v144, v112, v113
    v_exp_f32 v115, v115
    v_mfma_f32_32x32x16_bf16 v[128:143], v[212:215], v[44:47], v[128:143]
    buffer_load_dwordx4 a[140:143], v2, s[40:43], s71 offen offset:0
    v_exp_f32 v116, v116
    v_cvt_pk_bf16_f32 v145, v114, v115
    v_exp_f32 v117, v117
    v_exp_f32 v118, v118
    v_mfma_f32_32x32x16_bf16 a[16:31], a[232:235], a[228:231], a[16:31]
    v_cvt_pk_bf16_f32 v146, v116, v117
    v_exp_f32 v119, v119
    v_exp_f32 v120, v120
    v_cvt_pk_bf16_f32 v147, v118, v119
    v_exp_f32 v121, v121
    v_mfma_f32_32x32x16_bf16 v[64:79], v[216:219], v[152:155], v[64:79]
    v_exp_f32 v122, v122
    v_cvt_pk_bf16_f32 v148, v120, v121
    v_exp_f32 v123, v123
    v_exp_f32 v124, v124
    v_cvt_pk_bf16_f32 v149, v122, v123
    v_mfma_f32_32x32x16_bf16 v[64:79], v[220:223], v[156:159], v[64:79]
    v_exp_f32 v125, v125
    v_exp_f32 v126, v126
    v_exp_f32 v127, v127
    v_cvt_pk_bf16_f32 v150, v124, v125
    v_cvt_pk_bf16_f32 v151, v126, v127
    s_waitcnt vmcnt(22)
    v_mfma_f32_32x32x16_bf16 v[112:127], v[160:163], v[16:19], 0
    buffer_load_dwordx4 a[144:147], v2, s[40:43], s68 offen offset:1024
    v_exp_f32 v128, v128
    v_exp_f32 v129, v129
    v_exp_f32 v130, v130
    v_cvt_pk_bf16_f32 v152, v128, v129
    v_exp_f32 v131, v131
    v_mfma_f32_32x32x16_bf16 v[112:127], v[164:167], v[20:23], v[112:127]
    buffer_load_dwordx4 a[148:151], v2, s[40:43], s69 offen offset:1024
    v_exp_f32 v132, v132
    v_cvt_pk_bf16_f32 v153, v130, v131
    v_exp_f32 v133, v133
    v_exp_f32 v134, v134
    v_mfma_f32_32x32x16_bf16 a[32:47], a[236:239], a[224:227], a[32:47]
    v_cvt_pk_bf16_f32 v154, v132, v133
    v_exp_f32 v135, v135
    v_exp_f32 v136, v136
    v_cvt_pk_bf16_f32 v155, v134, v135
    v_exp_f32 v137, v137
    v_mfma_f32_32x32x16_bf16 v[80:95], v[216:219], v[144:147], v[80:95]
    v_exp_f32 v138, v138
    v_cvt_pk_bf16_f32 v156, v136, v137
    v_exp_f32 v139, v139
    v_exp_f32 v140, v140
    v_cvt_pk_bf16_f32 v157, v138, v139
    v_mfma_f32_32x32x16_bf16 v[80:95], v[220:223], v[148:151], v[80:95]
    v_exp_f32 v141, v141
    v_exp_f32 v142, v142
    v_exp_f32 v143, v143
    v_cvt_pk_bf16_f32 v158, v140, v141
    v_cvt_pk_bf16_f32 v159, v142, v143
    v_mfma_f32_32x32x16_bf16 v[128:143], v[160:163], v[24:27], 0
    buffer_load_dwordx4 a[152:155], v2, s[40:43], s70 offen offset:1024
    v_exp_f32 v112, v112
    v_exp_f32 v113, v113
    v_exp_f32 v114, v114
    v_cvt_pk_bf16_f32 v144, v112, v113
    v_exp_f32 v115, v115
    v_mfma_f32_32x32x16_bf16 v[128:143], v[164:167], v[28:31], v[128:143]
    buffer_load_dwordx4 a[156:159], v2, s[40:43], s71 offen offset:1024
    v_exp_f32 v116, v116
    v_cvt_pk_bf16_f32 v145, v114, v115
    v_exp_f32 v117, v117
    v_exp_f32 v118, v118
    v_mfma_f32_32x32x16_bf16 a[48:63], a[236:239], a[228:231], a[48:63]
    v_cvt_pk_bf16_f32 v146, v116, v117
    v_exp_f32 v119, v119
    v_exp_f32 v120, v120
    v_cvt_pk_bf16_f32 v147, v118, v119
    v_exp_f32 v121, v121
    v_mfma_f32_32x32x16_bf16 v[96:111], v[216:219], v[152:155], v[96:111]
    v_exp_f32 v122, v122
    v_cvt_pk_bf16_f32 v148, v120, v121
    v_exp_f32 v123, v123
    v_exp_f32 v124, v124
    v_cvt_pk_bf16_f32 v149, v122, v123
    v_mfma_f32_32x32x16_bf16 v[96:111], v[220:223], v[156:159], v[96:111]
    v_exp_f32 v125, v125
    v_exp_f32 v126, v126
    v_exp_f32 v127, v127
    v_cvt_pk_bf16_f32 v150, v124, v125
    v_cvt_pk_bf16_f32 v151, v126, v127
    v_mfma_f32_32x32x16_bf16 v[112:127], v[160:163], v[32:35], 0
    buffer_load_dwordx4 v[208:211], v250, s[40:43], s59 offen offset:0
    v_exp_f32 v128, v128
    v_exp_f32 v129, v129
    v_exp_f32 v130, v130
    v_cvt_pk_bf16_f32 v152, v128, v129
    v_exp_f32 v131, v131
    v_mfma_f32_32x32x16_bf16 v[112:127], v[164:167], v[36:39], v[112:127]
    buffer_load_dwordx4 v[212:215], v250, s[40:43], s59 offen offset:1024
    v_exp_f32 v132, v132
    v_cvt_pk_bf16_f32 v153, v130, v131
    v_exp_f32 v133, v133
    v_exp_f32 v134, v134
    v_mfma_f32_32x32x16_bf16 a[0:15], a[248:251], a[240:243], a[0:15]
    buffer_load_dwordx4 v[216:219], v250, s[40:43], s59 offen offset:2048
    v_cvt_pk_bf16_f32 v154, v132, v133
    v_exp_f32 v135, v135
    v_exp_f32 v136, v136
    v_cvt_pk_bf16_f32 v155, v134, v135
    v_exp_f32 v137, v137
    v_mfma_f32_32x32x16_bf16 v[48:63], v[168:171], v[144:147], v[48:63]
    buffer_load_dwordx4 v[220:223], v250, s[40:43], s59 offen offset:3072
    v_exp_f32 v138, v138
    v_cvt_pk_bf16_f32 v156, v136, v137
    v_exp_f32 v139, v139
    v_exp_f32 v140, v140
    v_cvt_pk_bf16_f32 v157, v138, v139
    v_mfma_f32_32x32x16_bf16 v[48:63], v[172:175], v[148:151], v[48:63]
    v_exp_f32 v141, v141
    v_exp_f32 v142, v142
    v_exp_f32 v143, v143
    v_cvt_pk_bf16_f32 v158, v140, v141
    v_cvt_pk_bf16_f32 v159, v142, v143
    v_mfma_f32_32x32x16_bf16 v[128:143], v[160:163], v[40:43], 0
    buffer_load_dwordx4 a[160:163], v2, s[40:43], s68 offen offset:2048
    v_exp_f32 v112, v112
    v_exp_f32 v113, v113
    v_exp_f32 v114, v114
    v_cvt_pk_bf16_f32 v144, v112, v113
    v_exp_f32 v115, v115
    v_mfma_f32_32x32x16_bf16 v[128:143], v[164:167], v[44:47], v[128:143]
    buffer_load_dwordx4 a[164:167], v2, s[40:43], s69 offen offset:2048
    v_exp_f32 v116, v116
    v_cvt_pk_bf16_f32 v145, v114, v115
    v_exp_f32 v117, v117
    v_exp_f32 v118, v118
    v_mfma_f32_32x32x16_bf16 a[16:31], a[248:251], a[244:247], a[16:31]
    v_cvt_pk_bf16_f32 v146, v116, v117
    v_exp_f32 v119, v119
    v_exp_f32 v120, v120
    v_cvt_pk_bf16_f32 v147, v118, v119
    v_exp_f32 v121, v121
    v_mfma_f32_32x32x16_bf16 v[64:79], v[168:171], v[152:155], v[64:79]
    v_exp_f32 v122, v122
    v_cvt_pk_bf16_f32 v148, v120, v121
    v_exp_f32 v123, v123
    v_exp_f32 v124, v124
    v_cvt_pk_bf16_f32 v149, v122, v123
    v_mfma_f32_32x32x16_bf16 v[64:79], v[172:175], v[156:159], v[64:79]
    v_exp_f32 v125, v125
    v_exp_f32 v126, v126
    v_exp_f32 v127, v127
    v_cvt_pk_bf16_f32 v150, v124, v125
    v_cvt_pk_bf16_f32 v151, v126, v127
    s_waitcnt vmcnt(22)
    v_mfma_f32_32x32x16_bf16 v[112:127], v[176:179], v[16:19], 0
    buffer_load_dwordx4 a[168:171], v2, s[40:43], s70 offen offset:2048
    v_exp_f32 v128, v128
    v_exp_f32 v129, v129
    v_exp_f32 v130, v130
    v_cvt_pk_bf16_f32 v152, v128, v129
    v_mfma_f32_32x32x16_bf16 a[32:47], a[252:255], a[240:243], a[32:47]
    buffer_load_dwordx4 a[172:175], v2, s[40:43], s71 offen offset:2048
    v_exp_f32 v131, v131
    v_exp_f32 v132, v132
    v_cvt_pk_bf16_f32 v153, v130, v131
    v_exp_f32 v133, v133
    v_mfma_f32_32x32x16_bf16 v[112:127], v[180:183], v[20:23], v[112:127]
    v_exp_f32 v134, v134
    v_cvt_pk_bf16_f32 v154, v132, v133
    v_exp_f32 v135, v135
    v_exp_f32 v136, v136
    v_mfma_f32_32x32x16_bf16 v[80:95], v[168:171], v[144:147], v[80:95]
    v_cvt_pk_bf16_f32 v155, v134, v135
    v_exp_f32 v137, v137
    v_exp_f32 v138, v138
    v_cvt_pk_bf16_f32 v156, v136, v137
    v_mfma_f32_32x32x16_bf16 a[48:63], a[252:255], a[244:247], a[48:63]
    v_exp_f32 v139, v139
    v_exp_f32 v140, v140
    v_cvt_pk_bf16_f32 v157, v138, v139
    v_exp_f32 v141, v141
    v_mfma_f32_32x32x16_bf16 v[80:95], v[172:175], v[148:151], v[80:95]
    v_exp_f32 v142, v142
    v_exp_f32 v143, v143
    v_cvt_pk_bf16_f32 v158, v140, v141
    v_cvt_pk_bf16_f32 v159, v142, v143
    v_mfma_f32_32x32x16_bf16 v[128:143], v[176:179], v[24:27], 0
    buffer_load_dwordx4 a[192:195], v2, s[40:43], s68 offen offset:3072
    v_exp_f32 v112, v112
    v_exp_f32 v113, v113
    v_exp_f32 v114, v114
    v_cvt_pk_bf16_f32 v144, v112, v113
    v_exp_f32 v115, v115
    v_mfma_f32_32x32x16_bf16 v[128:143], v[180:183], v[28:31], v[128:143]
    buffer_load_dwordx4 a[196:199], v2, s[40:43], s69 offen offset:3072
    v_exp_f32 v116, v116
    v_cvt_pk_bf16_f32 v145, v114, v115
    v_exp_f32 v117, v117
    v_exp_f32 v118, v118
    v_mfma_f32_32x32x16_bf16 a[0:15], v[232:235], v[224:227], a[0:15]
    v_cvt_pk_bf16_f32 v146, v116, v117
    v_exp_f32 v119, v119
    v_exp_f32 v120, v120
    v_cvt_pk_bf16_f32 v147, v118, v119
    v_exp_f32 v121, v121
    v_mfma_f32_32x32x16_bf16 v[96:111], v[168:171], v[152:155], v[96:111]
    v_exp_f32 v122, v122
    v_cvt_pk_bf16_f32 v148, v120, v121
    v_exp_f32 v123, v123
    v_exp_f32 v124, v124
    v_cvt_pk_bf16_f32 v149, v122, v123
    v_mfma_f32_32x32x16_bf16 v[96:111], v[172:175], v[156:159], v[96:111]
    v_exp_f32 v125, v125
    v_exp_f32 v126, v126
    v_exp_f32 v127, v127
    v_cvt_pk_bf16_f32 v150, v124, v125
    v_cvt_pk_bf16_f32 v151, v126, v127
    v_mfma_f32_32x32x16_bf16 v[112:127], v[176:179], v[32:35], 0
    buffer_load_dwordx4 v[160:163], v2, s[40:43], s21 offen offset:0
    v_exp_f32 v128, v128
    v_exp_f32 v129, v129
    v_exp_f32 v130, v130
    v_cvt_pk_bf16_f32 v152, v128, v129
    v_exp_f32 v131, v131
    v_mfma_f32_32x32x16_bf16 v[112:127], v[180:183], v[36:39], v[112:127]
    buffer_load_dwordx4 v[164:167], v2, s[40:43], s21 offen offset:1024
    v_exp_f32 v132, v132
    v_cvt_pk_bf16_f32 v153, v130, v131
    v_exp_f32 v133, v133
    v_exp_f32 v134, v134
    v_mfma_f32_32x32x16_bf16 a[16:31], v[232:235], v[228:231], a[16:31]
    buffer_load_dwordx4 v[168:171], v2, s[40:43], s21 offen offset:2048
    v_cvt_pk_bf16_f32 v154, v132, v133
    v_exp_f32 v135, v135
    v_exp_f32 v136, v136
    v_cvt_pk_bf16_f32 v155, v134, v135
    v_exp_f32 v137, v137
    v_mfma_f32_32x32x16_bf16 v[48:63], v[184:187], v[144:147], v[48:63]
    buffer_load_dwordx4 v[172:175], v2, s[40:43], s21 offen offset:3072
    v_exp_f32 v138, v138
    v_cvt_pk_bf16_f32 v156, v136, v137
    v_exp_f32 v139, v139
    v_exp_f32 v140, v140
    v_cvt_pk_bf16_f32 v157, v138, v139
    v_mfma_f32_32x32x16_bf16 v[48:63], v[188:191], v[148:151], v[48:63]
    v_exp_f32 v141, v141
    v_exp_f32 v142, v142
    v_exp_f32 v143, v143
    v_cvt_pk_bf16_f32 v158, v140, v141
    v_cvt_pk_bf16_f32 v159, v142, v143
    v_mfma_f32_32x32x16_bf16 v[128:143], v[176:179], v[40:43], 0
    buffer_load_dwordx4 a[176:179], v250, s[40:43], s21 offen offset:0
    v_exp_f32 v112, v112
    v_exp_f32 v113, v113
    v_exp_f32 v114, v114
    v_cvt_pk_bf16_f32 v144, v112, v113
    v_exp_f32 v115, v115
    v_mfma_f32_32x32x16_bf16 v[128:143], v[180:183], v[44:47], v[128:143]
    buffer_load_dwordx4 a[180:183], v250, s[40:43], s21 offen offset:1024
    v_exp_f32 v116, v116
    v_cvt_pk_bf16_f32 v145, v114, v115
    v_exp_f32 v117, v117
    v_exp_f32 v118, v118
    v_mfma_f32_32x32x16_bf16 a[32:47], v[236:239], v[224:227], a[32:47]
    buffer_load_dwordx4 a[184:187], v250, s[40:43], s21 offen offset:2048
    v_cvt_pk_bf16_f32 v146, v116, v117
    v_exp_f32 v119, v119
    v_exp_f32 v120, v120
    v_cvt_pk_bf16_f32 v147, v118, v119
    v_exp_f32 v121, v121
    v_mfma_f32_32x32x16_bf16 v[64:79], v[184:187], v[152:155], v[64:79]
    buffer_load_dwordx4 a[188:191], v250, s[40:43], s21 offen offset:3072
    v_exp_f32 v122, v122
    v_cvt_pk_bf16_f32 v148, v120, v121
    v_exp_f32 v123, v123
    v_exp_f32 v124, v124
    v_cvt_pk_bf16_f32 v149, v122, v123
    v_mfma_f32_32x32x16_bf16 v[64:79], v[188:191], v[156:159], v[64:79]
    v_exp_f32 v125, v125
    v_exp_f32 v126, v126
    v_exp_f32 v127, v127
    v_cvt_pk_bf16_f32 v150, v124, v125
    v_cvt_pk_bf16_f32 v151, v126, v127
    s_waitcnt vmcnt(24)
    v_mfma_f32_32x32x16_bf16 v[112:127], v[192:195], v[16:19], 0
    buffer_load_dwordx4 a[200:203], v2, s[40:43], s70 offen offset:3072
    v_exp_f32 v128, v128
    v_exp_f32 v129, v129
    v_exp_f32 v130, v130
    v_cvt_pk_bf16_f32 v152, v128, v129
    v_exp_f32 v131, v131
    v_mfma_f32_32x32x16_bf16 v[112:127], v[196:199], v[20:23], v[112:127]
    buffer_load_dwordx4 a[204:207], v2, s[40:43], s71 offen offset:3072
    v_exp_f32 v132, v132
    v_cvt_pk_bf16_f32 v153, v130, v131
    v_exp_f32 v133, v133
    v_exp_f32 v134, v134
    v_mfma_f32_32x32x16_bf16 a[48:63], v[236:239], v[228:231], a[48:63]
    v_cvt_pk_bf16_f32 v154, v132, v133
    v_exp_f32 v135, v135
    v_exp_f32 v136, v136
    v_cvt_pk_bf16_f32 v155, v134, v135
    v_exp_f32 v137, v137
    v_mfma_f32_32x32x16_bf16 v[80:95], v[184:187], v[144:147], v[80:95]
    v_exp_f32 v138, v138
    v_cvt_pk_bf16_f32 v156, v136, v137
    v_exp_f32 v139, v139
    v_exp_f32 v140, v140
    v_cvt_pk_bf16_f32 v157, v138, v139
    v_mfma_f32_32x32x16_bf16 v[80:95], v[188:191], v[148:151], v[80:95]
    v_exp_f32 v141, v141
    v_exp_f32 v142, v142
    v_exp_f32 v143, v143
    v_cvt_pk_bf16_f32 v158, v140, v141
    v_cvt_pk_bf16_f32 v159, v142, v143
    v_mfma_f32_32x32x16_bf16 v[128:143], v[192:195], v[24:27], 0
    buffer_load_dwordx4 a[208:211], v248, s[40:43], s68 offen offset:0
    v_exp_f32 v112, v112
    v_exp_f32 v113, v113
    v_exp_f32 v114, v114
    v_cvt_pk_bf16_f32 v144, v112, v113
    v_exp_f32 v115, v115
    v_mfma_f32_32x32x16_bf16 v[128:143], v[196:199], v[28:31], v[128:143]
    buffer_load_dwordx4 a[212:215], v248, s[40:43], s69 offen offset:0
    v_exp_f32 v116, v116
    v_cvt_pk_bf16_f32 v145, v114, v115
    v_exp_f32 v117, v117
    v_exp_f32 v118, v118
    v_mfma_f32_32x32x16_bf16 a[0:15], a[72:75], a[64:67], a[0:15]
    v_cvt_pk_bf16_f32 v146, v116, v117
    v_exp_f32 v119, v119
    v_exp_f32 v120, v120
    v_cvt_pk_bf16_f32 v147, v118, v119
    v_exp_f32 v121, v121
    v_mfma_f32_32x32x16_bf16 v[96:111], v[184:187], v[152:155], v[96:111]
    v_exp_f32 v122, v122
    v_cvt_pk_bf16_f32 v148, v120, v121
    v_exp_f32 v123, v123
    v_exp_f32 v124, v124
    v_cvt_pk_bf16_f32 v149, v122, v123
    v_mfma_f32_32x32x16_bf16 v[96:111], v[188:191], v[156:159], v[96:111]
    v_exp_f32 v125, v125
    v_exp_f32 v126, v126
    v_exp_f32 v127, v127
    v_cvt_pk_bf16_f32 v150, v124, v125
    v_cvt_pk_bf16_f32 v151, v126, v127
    v_mfma_f32_32x32x16_bf16 v[112:127], v[192:195], v[32:35], 0
    buffer_load_dwordx4 v[176:179], v248, s[40:43], s21 offen offset:0
    v_exp_f32 v128, v128
    v_exp_f32 v129, v129
    v_exp_f32 v130, v130
    v_cvt_pk_bf16_f32 v152, v128, v129
    v_exp_f32 v131, v131
    v_mfma_f32_32x32x16_bf16 v[112:127], v[196:199], v[36:39], v[112:127]
    buffer_load_dwordx4 v[180:183], v248, s[40:43], s21 offen offset:1024
    v_exp_f32 v132, v132
    v_cvt_pk_bf16_f32 v153, v130, v131
    v_exp_f32 v133, v133
    v_exp_f32 v134, v134
    v_mfma_f32_32x32x16_bf16 a[16:31], a[72:75], a[68:71], a[16:31]
    buffer_load_dwordx4 v[184:187], v248, s[40:43], s21 offen offset:2048
    v_cvt_pk_bf16_f32 v154, v132, v133
    v_exp_f32 v135, v135
    v_exp_f32 v136, v136
    v_cvt_pk_bf16_f32 v155, v134, v135
    v_exp_f32 v137, v137
    v_mfma_f32_32x32x16_bf16 v[48:63], v[200:203], v[144:147], v[48:63]
    buffer_load_dwordx4 v[188:191], v248, s[40:43], s21 offen offset:3072
    v_exp_f32 v138, v138
    v_cvt_pk_bf16_f32 v156, v136, v137
    v_exp_f32 v139, v139
    v_exp_f32 v140, v140
    v_cvt_pk_bf16_f32 v157, v138, v139
    v_mfma_f32_32x32x16_bf16 v[48:63], v[204:207], v[148:151], v[48:63]
    v_exp_f32 v141, v141
    v_exp_f32 v142, v142
    v_exp_f32 v143, v143
    v_cvt_pk_bf16_f32 v158, v140, v141
    v_cvt_pk_bf16_f32 v159, v142, v143
    v_mfma_f32_32x32x16_bf16 v[128:143], v[192:195], v[40:43], 0
    buffer_load_dwordx4 a[216:219], v248, s[40:43], s70 offen offset:0
    v_exp_f32 v112, v112
    v_exp_f32 v113, v113
    v_exp_f32 v114, v114
    v_cvt_pk_bf16_f32 v144, v112, v113
    v_exp_f32 v115, v115
    v_mfma_f32_32x32x16_bf16 v[128:143], v[196:199], v[44:47], v[128:143]
    buffer_load_dwordx4 a[220:223], v248, s[40:43], s71 offen offset:0
    v_exp_f32 v116, v116
    v_cvt_pk_bf16_f32 v145, v114, v115
    v_exp_f32 v117, v117
    v_exp_f32 v118, v118
    v_mfma_f32_32x32x16_bf16 a[32:47], a[76:79], a[64:67], a[32:47]
    v_cvt_pk_bf16_f32 v146, v116, v117
    v_exp_f32 v119, v119
    v_exp_f32 v120, v120
    v_cvt_pk_bf16_f32 v147, v118, v119
    v_exp_f32 v121, v121
    v_mfma_f32_32x32x16_bf16 v[64:79], v[200:203], v[152:155], v[64:79]
    v_exp_f32 v122, v122
    v_cvt_pk_bf16_f32 v148, v120, v121
    v_exp_f32 v123, v123
    v_exp_f32 v124, v124
    v_cvt_pk_bf16_f32 v149, v122, v123
    v_mfma_f32_32x32x16_bf16 v[64:79], v[204:207], v[156:159], v[64:79]
    v_exp_f32 v125, v125
    v_exp_f32 v126, v126
    v_exp_f32 v127, v127
    v_cvt_pk_bf16_f32 v150, v124, v125
    v_cvt_pk_bf16_f32 v151, v126, v127
    s_waitcnt vmcnt(20)
    v_mfma_f32_32x32x16_bf16 v[112:127], v[208:211], v[16:19], 0
    buffer_load_dwordx4 a[224:227], v248, s[40:43], s68 offen offset:1024
    v_exp_f32 v128, v128
    v_exp_f32 v129, v129
    v_exp_f32 v130, v130
    v_cvt_pk_bf16_f32 v152, v128, v129
    v_exp_f32 v131, v131
    v_mfma_f32_32x32x16_bf16 v[112:127], v[212:215], v[20:23], v[112:127]
    buffer_load_dwordx4 a[228:231], v248, s[40:43], s69 offen offset:1024
    v_exp_f32 v132, v132
    v_cvt_pk_bf16_f32 v153, v130, v131
    v_exp_f32 v133, v133
    v_exp_f32 v134, v134
    v_mfma_f32_32x32x16_bf16 a[48:63], a[76:79], a[68:71], a[48:63]
    v_cvt_pk_bf16_f32 v154, v132, v133
    v_exp_f32 v135, v135
    v_exp_f32 v136, v136
    v_cvt_pk_bf16_f32 v155, v134, v135
    v_exp_f32 v137, v137
    v_mfma_f32_32x32x16_bf16 v[80:95], v[200:203], v[144:147], v[80:95]
    v_exp_f32 v138, v138
    v_cvt_pk_bf16_f32 v156, v136, v137
    v_exp_f32 v139, v139
    v_exp_f32 v140, v140
    v_cvt_pk_bf16_f32 v157, v138, v139
    v_mfma_f32_32x32x16_bf16 v[80:95], v[204:207], v[148:151], v[80:95]
    v_exp_f32 v141, v141
    v_exp_f32 v142, v142
    v_exp_f32 v143, v143
    v_cvt_pk_bf16_f32 v158, v140, v141
    v_cvt_pk_bf16_f32 v159, v142, v143
    v_mfma_f32_32x32x16_bf16 v[128:143], v[208:211], v[24:27], 0
    buffer_load_dwordx4 a[232:235], v248, s[40:43], s70 offen offset:1024
    v_exp_f32 v112, v112
    v_exp_f32 v113, v113
    v_exp_f32 v114, v114
    v_cvt_pk_bf16_f32 v144, v112, v113
    v_exp_f32 v115, v115
    v_mfma_f32_32x32x16_bf16 v[128:143], v[212:215], v[28:31], v[128:143]
    buffer_load_dwordx4 a[236:239], v248, s[40:43], s71 offen offset:1024
    v_exp_f32 v116, v116
    v_cvt_pk_bf16_f32 v145, v114, v115
    v_exp_f32 v117, v117
    v_exp_f32 v118, v118
    v_mfma_f32_32x32x16_bf16 a[0:15], a[88:91], a[80:83], a[0:15]
    v_cvt_pk_bf16_f32 v146, v116, v117
    v_exp_f32 v119, v119
    v_exp_f32 v120, v120
    v_cvt_pk_bf16_f32 v147, v118, v119
    v_exp_f32 v121, v121
    v_mfma_f32_32x32x16_bf16 v[96:111], v[200:203], v[152:155], v[96:111]
    v_exp_f32 v122, v122
    v_cvt_pk_bf16_f32 v148, v120, v121
    v_exp_f32 v123, v123
    v_exp_f32 v124, v124
    v_cvt_pk_bf16_f32 v149, v122, v123
    v_mfma_f32_32x32x16_bf16 v[96:111], v[204:207], v[156:159], v[96:111]
    v_exp_f32 v125, v125
    v_exp_f32 v126, v126
    v_exp_f32 v127, v127
    v_cvt_pk_bf16_f32 v150, v124, v125
    v_cvt_pk_bf16_f32 v151, v126, v127
    v_mfma_f32_32x32x16_bf16 v[112:127], v[208:211], v[32:35], 0
    buffer_load_dwordx4 v[192:195], v249, s[40:43], s21 offen offset:0
    v_exp_f32 v128, v128
    v_exp_f32 v129, v129
    v_exp_f32 v130, v130
    v_cvt_pk_bf16_f32 v152, v128, v129
    v_exp_f32 v131, v131
    v_mfma_f32_32x32x16_bf16 v[112:127], v[212:215], v[36:39], v[112:127]
    buffer_load_dwordx4 v[196:199], v249, s[40:43], s21 offen offset:1024
    v_exp_f32 v132, v132
    v_cvt_pk_bf16_f32 v153, v130, v131
    v_exp_f32 v133, v133
    v_exp_f32 v134, v134
    v_mfma_f32_32x32x16_bf16 a[16:31], a[88:91], a[84:87], a[16:31]
    buffer_load_dwordx4 v[200:203], v249, s[40:43], s21 offen offset:2048
    v_cvt_pk_bf16_f32 v154, v132, v133
    v_exp_f32 v135, v135
    v_exp_f32 v136, v136
    v_cvt_pk_bf16_f32 v155, v134, v135
    v_exp_f32 v137, v137
    v_mfma_f32_32x32x16_bf16 v[48:63], v[216:219], v[144:147], v[48:63]
    buffer_load_dwordx4 v[204:207], v249, s[40:43], s21 offen offset:3072
    v_exp_f32 v138, v138
    v_cvt_pk_bf16_f32 v156, v136, v137
    v_exp_f32 v139, v139
    v_exp_f32 v140, v140
    v_cvt_pk_bf16_f32 v157, v138, v139
    v_mfma_f32_32x32x16_bf16 v[48:63], v[220:223], v[148:151], v[48:63]
    v_exp_f32 v141, v141
    v_exp_f32 v142, v142
    v_exp_f32 v143, v143
    v_cvt_pk_bf16_f32 v158, v140, v141
    v_cvt_pk_bf16_f32 v159, v142, v143
    v_mfma_f32_32x32x16_bf16 v[128:143], v[208:211], v[40:43], 0
    buffer_load_dwordx4 a[240:243], v248, s[40:43], s68 offen offset:2048
    v_exp_f32 v112, v112
    v_exp_f32 v113, v113
    v_exp_f32 v114, v114
    v_cvt_pk_bf16_f32 v144, v112, v113
    v_exp_f32 v115, v115
    v_mfma_f32_32x32x16_bf16 v[128:143], v[212:215], v[44:47], v[128:143]
    buffer_load_dwordx4 a[244:247], v248, s[40:43], s69 offen offset:2048
    v_exp_f32 v116, v116
    v_cvt_pk_bf16_f32 v145, v114, v115
    v_exp_f32 v117, v117
    v_exp_f32 v118, v118
    ds_write_b128 v251, v[48:51] offset:0
    v_mfma_f32_32x32x16_bf16 a[32:47], a[92:95], a[80:83], a[32:47]
    v_cvt_pk_bf16_f32 v146, v116, v117
    v_exp_f32 v119, v119
    v_exp_f32 v120, v120
    ds_write_b128 v251, v[52:55] offset:1024
    v_cvt_pk_bf16_f32 v147, v118, v119
    v_exp_f32 v121, v121
    v_mfma_f32_32x32x16_bf16 v[64:79], v[216:219], v[152:155], v[64:79]
    v_exp_f32 v122, v122
    ds_write_b128 v251, v[56:59] offset:2048
    v_cvt_pk_bf16_f32 v148, v120, v121
    v_exp_f32 v123, v123
    v_exp_f32 v124, v124
    ds_write_b128 v251, v[60:63] offset:3072
    v_cvt_pk_bf16_f32 v149, v122, v123
    v_mfma_f32_32x32x16_bf16 v[64:79], v[220:223], v[156:159], v[64:79]
    v_exp_f32 v125, v125
    v_exp_f32 v126, v126
    v_exp_f32 v127, v127
    v_cvt_pk_bf16_f32 v150, v124, v125
    v_cvt_pk_bf16_f32 v151, v126, v127
    v_mfma_f32_32x32x16_bf16 a[48:63], a[92:95], a[84:87], a[48:63]
    buffer_load_dwordx4 a[248:251], v248, s[40:43], s70 offen offset:2048
    v_exp_f32 v128, v128
    v_exp_f32 v129, v129
    v_exp_f32 v130, v130
    ds_write_b128 v252, v[64:67] offset:0
    v_cvt_pk_bf16_f32 v152, v128, v129
    v_exp_f32 v131, v131
    v_exp_f32 v132, v132
    ds_write_b128 v252, v[68:71] offset:1024
    v_cvt_pk_bf16_f32 v153, v130, v131
    v_exp_f32 v133, v133
    v_mfma_f32_32x32x16_bf16 v[80:95], v[216:219], v[144:147], v[80:95]
    buffer_load_dwordx4 a[252:255], v248, s[40:43], s71 offen offset:2048
    v_exp_f32 v134, v134
    ds_write_b128 v252, v[72:75] offset:2048
    v_cvt_pk_bf16_f32 v154, v132, v133
    v_exp_f32 v135, v135
    v_exp_f32 v136, v136
    ds_write_b128 v252, v[76:79] offset:3072
    v_cvt_pk_bf16_f32 v155, v134, v135
    v_exp_f32 v137, v137
    v_exp_f32 v138, v138
    v_cvt_pk_bf16_f32 v156, v136, v137
    v_mfma_f32_32x32x16_bf16 v[80:95], v[220:223], v[148:151], v[80:95]
    v_exp_f32 v139, v139
    v_exp_f32 v140, v140
    v_cvt_pk_bf16_f32 v157, v138, v139
    v_exp_f32 v141, v141
    v_exp_f32 v142, v142
    v_exp_f32 v143, v143
    v_cvt_pk_bf16_f32 v158, v140, v141
    v_cvt_pk_bf16_f32 v159, v142, v143
    v_mfma_f32_32x32x16_bf16 v[96:111], v[216:219], v[152:155], v[96:111]
    ds_write_b128 v253, v[80:83] offset:0
    ds_write_b128 v253, v[84:87] offset:1024
    v_mfma_f32_32x32x16_bf16 v[96:111], v[220:223], v[156:159], v[96:111]
    ds_write_b128 v253, v[88:91] offset:2048
    ds_write_b128 v253, v[92:95] offset:3072
    v_mfma_f32_32x32x16_bf16 a[0:15], a[104:107], a[96:99], a[0:15]
    buffer_load_dwordx4 v[224:227], v248, s[40:43], s68 offen offset:3072
    v_mfma_f32_32x32x16_bf16 a[16:31], a[104:107], a[100:103], a[16:31]
    buffer_load_dwordx4 v[228:231], v248, s[40:43], s69 offen offset:3072
    v_add_f32 v8, v60, v76
    v_add_f32 v9, v92, v108
    v_add_f32 v8, v8, v9
    v_cmp_nge_f32 vcc, s22, v8
    v_mov_b32 v10, 98304
    s_nop 0
    v_mov_b32 v8, vcc_hi
    ds_write_b32 v3, v8
    v_mfma_f32_32x32x16_bf16 a[32:47], a[108:111], a[96:99], a[32:47]
    buffer_load_dwordx4 v[232:235], v248, s[40:43], s70 offen offset:3072
    v_mfma_f32_32x32x16_bf16 a[48:63], a[108:111], a[100:103], a[48:63]
    buffer_load_dwordx4 v[236:239], v248, s[40:43], s71 offen offset:3072
    s_waitcnt lgkmcnt(0)
    s_barrier
    ds_read_b128 v[60:63], v254 offset:3072
    ds_read_b128 v[76:79], v254 offset:7168
    v_mfma_f32_32x32x16_bf16 a[0:15], a[120:123], a[112:115], a[0:15]
    buffer_load_dwordx4 a[64:67], v249, s[40:43], s68 offen offset:0
    ds_read_b128 v[92:95], v254 offset:11264
    ds_read_b128 v[48:51], v254 offset:0
    v_mfma_f32_32x32x16_bf16 a[16:31], a[120:123], a[116:119], a[16:31]
    buffer_load_dwordx4 a[68:71], v249, s[40:43], s69 offen offset:0
    ds_read_b128 v[64:67], v254 offset:4096
    ds_read_b128 v[80:83], v254 offset:8192
    v_mfma_f32_32x32x16_bf16 a[32:47], a[124:127], a[112:115], a[32:47]
    buffer_load_dwordx4 a[72:75], v249, s[40:43], s70 offen offset:0
    ds_read_b128 v[52:55], v254 offset:1024
    ds_read_b128 v[68:71], v254 offset:5120
    v_mfma_f32_32x32x16_bf16 a[48:63], a[124:127], a[116:119], a[48:63]
    buffer_load_dwordx4 a[76:79], v249, s[40:43], s71 offen offset:0
    ds_read_b128 v[84:87], v254 offset:9216
    ds_read_b128 v[56:59], v254 offset:2048
    v_mfma_f32_32x32x16_bf16 a[0:15], a[136:139], a[128:131], a[0:15]
    buffer_load_dwordx4 a[80:83], v249, s[40:43], s68 offen offset:1024
    ds_read_b128 v[72:75], v254 offset:6144
    ds_read_b128 v[88:91], v254 offset:10240
    v_mfma_f32_32x32x16_bf16 a[16:31], a[136:139], a[132:135], a[16:31]
    buffer_load_dwordx4 a[84:87], v249, s[40:43], s69 offen offset:1024
    ds_read_b128 v[12:15], v10
    s_waitcnt lgkmcnt(10)
    v_mfma_f32_32x32x16_bf16 a[32:47], a[140:143], a[128:131], a[32:47]
    buffer_load_dwordx4 a[88:91], v249, s[40:43], s70 offen offset:1024
    v_add_f32 v60, v60, v76
    v_add_f32 v61, v61, v77
    v_add_f32 v62, v62, v78
    v_add_f32 v63, v63, v79
    v_add_f32 v108, v108, v92
    v_add_f32 v109, v109, v93
    v_mfma_f32_32x32x16_bf16 a[48:63], a[140:143], a[132:135], a[48:63]
    buffer_load_dwordx4 a[92:95], v249, s[40:43], s71 offen offset:1024
    v_add_f32 v110, v110, v94
    v_add_f32 v111, v111, v95
    v_add_f32 v108, v108, v60
    v_add_f32 v109, v109, v61
    v_add_f32 v110, v110, v62
    v_add_f32 v111, v111, v63
    v_mfma_f32_32x32x16_bf16 a[0:15], a[152:155], a[144:147], a[0:15]
    buffer_load_dwordx4 a[96:99], v249, s[40:43], s68 offen offset:2048
    v_mov_b32 v9, v108
    v_mov_b32 v11, v108
    s_waitcnt lgkmcnt(7)
    v_add_f32 v48, v48, v64
    v_add_f32 v49, v49, v65
    v_add_f32 v50, v50, v66
    v_add_f32 v51, v51, v67
    v_mfma_f32_32x32x16_bf16 a[16:31], a[152:155], a[148:151], a[16:31]
    buffer_load_dwordx4 a[100:103], v249, s[40:43], s69 offen offset:2048
    v_add_f32 v96, v96, v80
    v_add_f32 v97, v97, v81
    v_add_f32 v98, v98, v82
    v_add_f32 v99, v99, v83
    v_add_f32 v96, v96, v48
    v_add_f32 v97, v97, v49
    v_mfma_f32_32x32x16_bf16 a[32:47], a[156:159], a[144:147], a[32:47]
    buffer_load_dwordx4 a[104:107], v249, s[40:43], s70 offen offset:2048
    v_add_f32 v98, v98, v50
    v_add_f32 v99, v99, v51
    v_permlane32_swap_b32 v9, v11
    s_waitcnt lgkmcnt(4)
    v_add_f32 v52, v52, v68
    v_add_f32 v53, v53, v69
    v_mfma_f32_32x32x16_bf16 a[48:63], a[156:159], a[148:151], a[48:63]
    buffer_load_dwordx4 a[108:111], v249, s[40:43], s71 offen offset:2048
    v_add_f32 v54, v54, v70
    v_add_f32 v55, v55, v71
    v_add_f32 v100, v100, v84
    v_add_f32 v101, v101, v85
    v_add_f32 v102, v102, v86
    v_add_f32 v103, v103, v87
    v_mfma_f32_32x32x16_bf16 a[0:15], a[168:171], a[160:163], a[0:15]
    buffer_load_dwordx4 a[112:115], v249, s[40:43], s68 offen offset:3072
    v_add_f32 v100, v100, v52
    v_add_f32 v101, v101, v53
    v_add_f32 v102, v102, v54
    v_add_f32 v103, v103, v55
    v_rcp_f32 v10, v11
    s_waitcnt lgkmcnt(1)
    v_mfma_f32_32x32x16_bf16 a[16:31], a[168:171], a[164:167], a[16:31]
    buffer_load_dwordx4 a[116:119], v249, s[40:43], s69 offen offset:3072
    v_add_f32 v56, v56, v72
    v_add_f32 v57, v57, v73
    v_add_f32 v58, v58, v74
    v_add_f32 v59, v59, v75
    v_add_f32 v104, v104, v88
    v_add_f32 v105, v105, v89
    v_mfma_f32_32x32x16_bf16 a[32:47], a[172:175], a[160:163], a[32:47]
    buffer_load_dwordx4 a[120:123], v249, s[40:43], s70 offen offset:3072
    v_add_f32 v106, v106, v90
    v_add_f32 v107, v107, v91
    v_add_f32 v104, v104, v56
    v_add_f32 v105, v105, v57
    v_add_f32 v106, v106, v58
    v_add_f32 v107, v107, v59
    v_mfma_f32_32x32x16_bf16 a[48:63], a[172:175], a[164:167], a[48:63]
    buffer_load_dwordx4 a[124:127], v249, s[40:43], s71 offen offset:3072
    s_waitcnt lgkmcnt(0)
    v_or_b32 v12, v12, v13
    v_or3_b32 v12, v12, v14, v15
    v_mul_f32 v96, v96, v10
    v_mul_f32 v97, v97, v10
    v_mul_f32 v98, v98, v10
    v_mul_f32 v99, v99, v10
    v_mul_f32 v100, v100, v10
    s_waitcnt vmcnt(20)
    v_mfma_f32_32x32x16_bf16 a[0:15], a[200:203], a[192:195], a[0:15]
    v_mul_f32 v101, v101, v10
    v_mul_f32 v102, v102, v10
    v_mul_f32 v103, v103, v10
    v_mul_f32 v104, v104, v10
    v_mul_f32 v105, v105, v10
    v_mul_f32 v106, v106, v10
    v_mfma_f32_32x32x16_bf16 a[16:31], a[200:203], a[196:199], a[16:31]
    v_mul_f32 v107, v107, v10
    v_mul_f32 v108, v108, v10
    v_mul_f32 v109, v109, v10
    v_mul_f32 v110, v110, v10
    v_mul_f32 v111, v111, v10
    v_readfirstlane_b32 s63, v12
    v_mfma_f32_32x32x16_bf16 a[32:47], a[204:207], a[192:195], a[32:47]
    v_cvt_pk_bf16_f32 v48, v96, v97
    v_cvt_pk_bf16_f32 v49, v98, v99
    v_cvt_pk_bf16_f32 v50, v100, v101
    v_cvt_pk_bf16_f32 v51, v102, v103
    v_cvt_pk_bf16_f32 v52, v104, v105
    v_cvt_pk_bf16_f32 v53, v106, v107
    v_mfma_f32_32x32x16_bf16 a[48:63], a[204:207], a[196:199], a[48:63]
    v_cvt_pk_bf16_f32 v54, v108, v109
    v_cvt_pk_bf16_f32 v55, v110, v111
    v_min_u32 v48, s23, v48
    v_min_u32 v51, s23, v51
    v_min_u32 v52, s23, v52
    v_min_u32 v55, s23, v55
    v_mfma_f32_32x32x16_bf16 a[0:15], a[216:219], a[208:211], a[0:15]
    s_cmp_lg_u32 s63, 0
    s_cselect_b32 s63, 1, 0
    s_cmp_gt_u32 s63, s60
    s_cbranch_scc1 k2_fb
    buffer_store_dwordx4 v[48:51], v255, s[40:43], s75 offen sc1
    buffer_store_dwordx4 v[52:55], v255, s[40:43], s75 offen offset:1024 sc1
    s_cmp_ge_u32 s5, 7
    s_cbranch_scc1 k2_fin
    v_mfma_f32_32x32x16_bf16 a[16:31], a[216:219], a[212:215], a[16:31]
    v_mfma_f32_32x32x16_bf16 a[32:47], a[220:223], a[208:211], a[32:47]
    v_mfma_f32_32x32x16_bf16 a[48:63], a[220:223], a[212:215], a[48:63]
    v_mfma_f32_32x32x16_bf16 a[0:15], a[232:235], a[224:227], a[0:15]
    v_mfma_f32_32x32x16_bf16 a[16:31], a[232:235], a[228:231], a[16:31]
    v_mfma_f32_32x32x16_bf16 a[32:47], a[236:239], a[224:227], a[32:47]
    v_mfma_f32_32x32x16_bf16 a[48:63], a[236:239], a[228:231], a[48:63]
    v_mfma_f32_32x32x16_bf16 a[0:15], a[248:251], a[240:243], a[0:15]
    v_mfma_f32_32x32x16_bf16 a[16:31], a[248:251], a[244:247], a[16:31]
    v_mfma_f32_32x32x16_bf16 a[32:47], a[252:255], a[240:243], a[32:47]
    v_mfma_f32_32x32x16_bf16 a[48:63], a[252:255], a[244:247], a[48:63]
    s_waitcnt vmcnt(19)
    v_mfma_f32_32x32x16_bf16 a[0:15], v[232:235], v[224:227], a[0:15]
    v_mfma_f32_32x32x16_bf16 a[16:31], v[232:235], v[228:231], a[16:31]
    s_waitcnt vmcnt(18)
    v_mfma_f32_32x32x16_bf16 a[32:47], v[236:239], v[224:227], a[32:47]
    v_mfma_f32_32x32x16_bf16 a[48:63], v[236:239], v[228:231], a[48:63]
    s_waitcnt vmcnt(15)
    v_mfma_f32_32x32x16_bf16 a[0:15], a[72:75], a[64:67], a[0:15]
    v_mfma_f32_32x32x16_bf16 a[16:31], a[72:75], a[68:71], a[16:31]
    s_waitcnt vmcnt(14)
    v_mfma_f32_32x32x16_bf16 a[32:47], a[76:79], a[64:67], a[32:47]
    v_mfma_f32_32x32x16_bf16 a[48:63], a[76:79], a[68:71], a[48:63]
    s_waitcnt vmcnt(11)
    v_mfma_f32_32x32x16_bf16 a[0:15], a[88:91], a[80:83], a[0:15]
    v_mfma_f32_32x32x16_bf16 a[16:31], a[88:91], a[84:87], a[16:31]
    s_waitcnt vmcnt(10)
    v_mfma_f32_32x32x16_bf16 a[32:47], a[92:95], a[80:83], a[32:47]
    v_mfma_f32_32x32x16_bf16 a[48:63], a[92:95], a[84:87], a[48:63]
    s_waitcnt vmcnt(7)
    v_mfma_f32_32x32x16_bf16 a[0:15], a[104:107], a[96:99], a[0:15]
    v_mfma_f32_32x32x16_bf16 a[16:31], a[104:107], a[100:103], a[16:31]
    s_waitcnt vmcnt(6)
    v_mfma_f32_32x32x16_bf16 a[32:47], a[108:111], a[96:99], a[32:47]
    v_mfma_f32_32x32x16_bf16 a[48:63], a[108:111], a[100:103], a[48:63]
    s_waitcnt vmcnt(3)
    v_mfma_f32_32x32x16_bf16 a[0:15], a[120:123], a[112:115], a[0:15]
    v_mfma_f32_32x32x16_bf16 a[16:31], a[120:123], a[116:119], a[16:31]
    s_waitcnt vmcnt(2)
    v_mfma_f32_32x32x16_bf16 a[32:47], a[124:127], a[112:115], a[32:47]
    v_mfma_f32_32x32x16_bf16 a[48:63], a[124:127], a[116:119], a[48:63]
    buffer_load_dwordx4 v[112:115], v2, s[40:43], s76 offen offset:0 sc1
    buffer_load_dwordx4 v[116:119], v2, s[40:43], s77 offen offset:0 sc1
    buffer_load_dwordx4 v[120:123], v2, s[40:43], s76 offen offset:1024 sc1
    buffer_load_dwordx4 v[124:127], v2, s[40:43], s77 offen offset:1024 sc1
    buffer_load_dwordx4 v[128:131], v2, s[40:43], s76 offen offset:2048 sc1
    buffer_load_dwordx4 v[132:135], v2, s[40:43], s77 offen offset:2048 sc1
    buffer_load_dwordx4 v[136:139], v2, s[40:43], s76 offen offset:3072 sc1
    buffer_load_dwordx4 v[140:143], v2, s[40:43], s77 offen offset:3072 sc1
    buffer_load_dwordx4 v[144:147], v248, s[40:43], s76 offen offset:0 sc1
    buffer_load_dwordx4 v[148:151], v248, s[40:43], s77 offen offset:0 sc1
    buffer_load_dwordx4 v[152:155], v248, s[40:43], s76 offen offset:1024 sc1
    buffer_load_dwordx4 v[156:159], v248, s[40:43], s77 offen offset:1024 sc1
    buffer_load_dwordx4 v[208:211], v248, s[40:43], s76 offen offset:2048 sc1
    buffer_load_dwordx4 v[212:215], v248, s[40:43], s77 offen offset:2048 sc1
    buffer_load_dwordx4 v[216:219], v248, s[40:43], s76 offen offset:3072 sc1
    buffer_load_dwordx4 v[220:223], v248, s[40:43], s77 offen offset:3072 sc1
    s_nop 15
    s_branch k2_poll2
k2_poll:
    buffer_load_dwordx4 v[112:115], v2, s[40:43], s76 offen offset:0 sc1
    buffer_load_dwordx4 v[116:119], v2, s[40:43], s77 offen offset:0 sc1
    buffer_load_dwordx4 v[120:123], v2, s[40:43], s76 offen offset:1024 sc1
    buffer_load_dwordx4 v[124:127], v2, s[40:43], s77 offen offset:1024 sc1
    buffer_load_dwordx4 v[128:131], v2, s[40:43], s76 offen offset:2048 sc1
    buffer_load_dwordx4 v[132:135], v2, s[40:43], s77 offen offset:2048 sc1
    buffer_load_dwordx4 v[136:139], v2, s[40:43], s76 offen offset:3072 sc1
    buffer_load_dwordx4 v[140:143], v2, s[40:43], s77 offen offset:3072 sc1
    buffer_load_dwordx4 v[144:147], v248, s[40:43], s76 offen offset:0 sc1
    buffer_load_dwordx4 v[148:151], v248, s[40:43], s77 offen offset:0 sc1
    buffer_load_dwordx4 v[152:155], v248, s[40:43], s76 offen offset:1024 sc1
    buffer_load_dwordx4 v[156:159], v248, s[40:43], s77 offen offset:1024 sc1
    buffer_load_dwordx4 v[208:211], v248, s[40:43], s76 offen offset:2048 sc1
    buffer_load_dwordx4 v[212:215], v248, s[40:43], s77 offen offset:2048 sc1
    buffer_load_dwordx4 v[216:219], v248, s[40:43], s76 offen offset:3072 sc1
    buffer_load_dwordx4 v[220:223], v248, s[40:43], s77 offen offset:3072 sc1
k2_poll2:
    v_mov_b32 v9, 0
    s_waitcnt vmcnt(14)
    v_mfma_f32_32x32x16_bf16 a[192:207], v[160:163], v[112:115], a[0:15]
    v_max3_u32 v9, v9, v112, v115
    v_mfma_f32_32x32x16_bf16 a[208:223], v[160:163], v[116:119], a[16:31]
    v_max3_u32 v9, v9, v116, v119
    v_mfma_f32_32x32x16_bf16 a[224:239], v[164:167], v[112:115], a[32:47]
    v_mfma_f32_32x32x16_bf16 a[240:255], v[164:167], v[116:119], a[48:63]
    s_waitcnt vmcnt(12)
    v_mfma_f32_32x32x16_bf16 a[192:207], v[168:171], v[120:123], a[192:207]
    v_max3_u32 v9, v9, v120, v123
    v_mfma_f32_32x32x16_bf16 a[208:223], v[168:171], v[124:127], a[208:223]
    v_max3_u32 v9, v9, v124, v127
    v_mfma_f32_32x32x16_bf16 a[224:239], v[172:175], v[120:123], a[224:239]
    v_mfma_f32_32x32x16_bf16 a[240:255], v[172:175], v[124:127], a[240:255]
    s_waitcnt vmcnt(10)
    v_mfma_f32_32x32x16_bf16 a[192:207], v[176:179], v[128:131], a[192:207]
    v_max3_u32 v9, v9, v128, v131
    v_mfma_f32_32x32x16_bf16 a[208:223], v[176:179], v[132:135], a[208:223]
    v_max3_u32 v9, v9, v132, v135
    v_mfma_f32_32x32x16_bf16 a[224:239], v[180:183], v[128:131], a[224:239]
    v_mfma_f32_32x32x16_bf16 a[240:255], v[180:183], v[132:135], a[240:255]
    s_waitcnt vmcnt(8)
    v_mfma_f32_32x32x16_bf16 a[192:207], v[184:187], v[136:139], a[192:207]
    v_max3_u32 v9, v9, v136, v139
    v_mfma_f32_32x32x16_bf16 a[208:223], v[184:187], v[140:143], a[208:223]
    v_max3_u32 v9, v9, v140, v143
    v_mfma_f32_32x32x16_bf16 a[224:239], v[188:191], v[136:139], a[224:239]
    v_mfma_f32_32x32x16_bf16 a[240:255], v[188:191], v[140:143], a[240:255]
    s_waitcnt vmcnt(6)
    v_mfma_f32_32x32x16_bf16 a[192:207], v[192:195], v[144:147], a[192:207]
    v_max3_u32 v9, v9, v144, v147
    v_mfma_f32_32x32x16_bf16 a[208:223], v[192:195], v[148:151], a[208:223]
    v_max3_u32 v9, v9, v148, v151
    v_mfma_f32_32x32x16_bf16 a[224:239], v[196:199], v[144:147], a[224:239]
    v_mfma_f32_32x32x16_bf16 a[240:255], v[196:199], v[148:151], a[240:255]
    s_waitcnt vmcnt(4)
    v_mfma_f32_32x32x16_bf16 a[192:207], v[200:203], v[152:155], a[192:207]
    v_max3_u32 v9, v9, v152, v155
    v_mfma_f32_32x32x16_bf16 a[208:223], v[200:203], v[156:159], a[208:223]
    v_max3_u32 v9, v9, v156, v159
    v_mfma_f32_32x32x16_bf16 a[224:239], v[204:207], v[152:155], a[224:239]
    v_mfma_f32_32x32x16_bf16 a[240:255], v[204:207], v[156:159], a[240:255]
    s_waitcnt vmcnt(2)
    v_mfma_f32_32x32x16_bf16 a[192:207], a[176:179], v[208:211], a[192:207]
    v_max3_u32 v9, v9, v208, v211
    v_mfma_f32_32x32x16_bf16 a[208:223], a[176:179], v[212:215], a[208:223]
    v_max3_u32 v9, v9, v212, v215
    v_mfma_f32_32x32x16_bf16 a[224:239], a[180:183], v[208:211], a[224:239]
    v_mfma_f32_32x32x16_bf16 a[240:255], a[180:183], v[212:215], a[240:255]
    s_waitcnt vmcnt(0)
    v_mfma_f32_32x32x16_bf16 a[192:207], a[184:187], v[216:219], a[192:207]
    v_max3_u32 v9, v9, v216, v219
    v_mfma_f32_32x32x16_bf16 a[208:223], a[184:187], v[220:223], a[208:223]
    v_max3_u32 v9, v9, v220, v223
    v_mfma_f32_32x32x16_bf16 a[224:239], a[188:191], v[216:219], a[224:239]
    v_mfma_f32_32x32x16_bf16 a[240:255], a[188:191], v[220:223], a[240:255]
    v_cmp_eq_u32 vcc, -1, v9
    s_add_u32 s80, s80, 1
    s_cmp_gt_u32 s80, 0x40000
    s_cbranch_scc1 k2_go
    s_nop 1
    s_cbranch_vccnz k2_poll
k2_go:
    s_nop 7
    ds_write_b128 v251, a[192:195] offset:49152
    ds_write_b128 v251, a[196:199] offset:50176
    ds_write_b128 v251, a[200:203] offset:51200
    ds_write_b128 v251, a[204:207] offset:52224
    ds_write_b128 v252, a[208:211] offset:49152
    ds_write_b128 v252, a[212:215] offset:50176
    ds_write_b128 v252, a[216:219] offset:51200
    ds_write_b128 v252, a[220:223] offset:52224
    ds_write_b128 v253, a[224:227] offset:49152
    ds_write_b128 v253, a[228:231] offset:50176
    ds_write_b128 v253, a[232:235] offset:51200
    ds_write_b128 v253, a[236:239] offset:52224
    v_accvgpr_read_b32 v96, a240
    v_accvgpr_read_b32 v97, a241
    v_accvgpr_read_b32 v98, a242
    v_accvgpr_read_b32 v99, a243
    v_accvgpr_read_b32 v100, a244
    v_accvgpr_read_b32 v101, a245
    v_accvgpr_read_b32 v102, a246
    v_accvgpr_read_b32 v103, a247
    v_accvgpr_read_b32 v104, a248
    v_accvgpr_read_b32 v105, a249
    v_accvgpr_read_b32 v106, a250
    v_accvgpr_read_b32 v107, a251
    v_accvgpr_read_b32 v108, a252
    v_accvgpr_read_b32 v109, a253
    v_accvgpr_read_b32 v110, a254
    v_accvgpr_read_b32 v111, a255
    v_lshlrev_b32 v224, 16, v240
    v_and_b32 v225, s72, v240
    v_lshlrev_b32 v226, 16, v241
    v_and_b32 v227, s72, v241
    v_lshlrev_b32 v228, 16, v242
    v_and_b32 v229, s72, v242
    v_lshlrev_b32 v230, 16, v243
    v_and_b32 v231, s72, v243
    v_lshlrev_b32 v232, 16, v244
    v_and_b32 v233, s72, v244
    v_lshlrev_b32 v234, 16, v245
    v_and_b32 v235, s72, v245
    v_lshlrev_b32 v236, 16, v246
    v_and_b32 v237, s72, v246
    v_lshlrev_b32 v238, 16, v247
    v_and_b32 v239, s72, v247
    s_nop 0
    v_permlane32_swap_b32 v224, v228
    v_permlane32_swap_b32 v225, v229
    v_permlane32_swap_b32 v226, v230
    v_permlane32_swap_b32 v227, v231
    v_permlane32_swap_b32 v232, v236
    v_permlane32_swap_b32 v233, v237
    v_permlane32_swap_b32 v234, v238
    v_permlane32_swap_b32 v235, v239
    v_pk_add_f32 v[96:97], v[96:97], v[224:225]
    v_pk_add_f32 v[98:99], v[98:99], v[226:227]
    v_pk_add_f32 v[100:101], v[100:101], v[228:229]
    v_pk_add_f32 v[102:103], v[102:103], v[230:231]
    v_pk_add_f32 v[104:105], v[104:105], v[232:233]
    v_pk_add_f32 v[106:107], v[106:107], v[234:235]
    v_pk_add_f32 v[108:109], v[108:109], v[236:237]
    v_pk_add_f32 v[110:111], v[110:111], v[238:239]
    s_waitcnt lgkmcnt(0)
    s_barrier
    ds_read_b128 v[48:51], v254 offset:49152
    ds_read_b128 v[64:67], v254 offset:53248
    ds_read_b128 v[80:83], v254 offset:57344
    ds_read_b128 v[52:55], v254 offset:50176
    ds_read_b128 v[68:71], v254 offset:54272
    ds_read_b128 v[84:87], v254 offset:58368
    ds_read_b128 v[56:59], v254 offset:51200
    ds_read_b128 v[72:75], v254 offset:55296
    ds_read_b128 v[88:91], v254 offset:59392
    ds_read_b128 v[60:63], v254 offset:52224
    ds_read_b128 v[76:79], v254 offset:56320
    ds_read_b128 v[92:95], v254 offset:60416
    s_waitcnt lgkmcnt(9)
    v_pk_add_f32 v[48:49], v[48:49], v[64:65]
    v_pk_add_f32 v[50:51], v[50:51], v[66:67]
    v_pk_add_f32 v[96:97], v[96:97], v[80:81]
    v_pk_add_f32 v[98:99], v[98:99], v[82:83]
    v_pk_add_f32 v[96:97], v[96:97], v[48:49]
    v_pk_add_f32 v[98:99], v[98:99], v[50:51]
    s_waitcnt lgkmcnt(6)
    v_pk_add_f32 v[52:53], v[52:53], v[68:69]
    v_pk_add_f32 v[54:55], v[54:55], v[70:71]
    v_pk_add_f32 v[100:101], v[100:101], v[84:85]
    v_pk_add_f32 v[102:103], v[102:103], v[86:87]
    v_pk_add_f32 v[100:101], v[100:101], v[52:53]
    v_pk_add_f32 v[102:103], v[102:103], v[54:55]
    s_waitcnt lgkmcnt(3)
    v_pk_add_f32 v[56:57], v[56:57], v[72:73]
    v_pk_add_f32 v[58:59], v[58:59], v[74:75]
    v_pk_add_f32 v[104:105], v[104:105], v[88:89]
    v_pk_add_f32 v[106:107], v[106:107], v[90:91]
    v_pk_add_f32 v[104:105], v[104:105], v[56:57]
    v_pk_add_f32 v[106:107], v[106:107], v[58:59]
    s_waitcnt lgkmcnt(0)
    v_pk_add_f32 v[60:61], v[60:61], v[76:77]
    v_pk_add_f32 v[62:63], v[62:63], v[78:79]
    v_pk_add_f32 v[108:109], v[108:109], v[92:93]
    v_pk_add_f32 v[110:111], v[110:111], v[94:95]
    v_pk_add_f32 v[108:109], v[108:109], v[60:61]
    v_pk_add_f32 v[110:111], v[110:111], v[62:63]
    v_cvt_pk_bf16_f32 v56, v96, v97
    v_cvt_pk_bf16_f32 v57, v98, v99
    v_cvt_pk_bf16_f32 v58, v100, v101
    v_cvt_pk_bf16_f32 v59, v102, v103
    v_cvt_pk_bf16_f32 v60, v104, v105
    v_cvt_pk_bf16_f32 v61, v106, v107
    v_cvt_pk_bf16_f32 v62, v108, v109
    v_cvt_pk_bf16_f32 v63, v110, v111
    s_nop 0
    v_permlane32_swap_b32 v56, v58
    v_permlane32_swap_b32 v57, v59
    v_permlane32_swap_b32 v60, v62
    v_permlane32_swap_b32 v61, v63
    buffer_store_dwordx4 v[56:59], v7, s[32:35], s74 offen
    buffer_store_dwordx4 v[60:63], v7, s[32:35], s74 offen offset:32
k2_fin:
k2_done:
    s_endpgm
k2_fb:
    s_mov_b32 s60, 1
    s_waitcnt vmcnt(0) lgkmcnt(0)
    s_mov_b32 exec_lo, 0
    v_mov_b32 v22, 0
    v_mov_b32 v23, 0
    v_mov_b32 v30, 0
    v_mov_b32 v31, 0
    v_mov_b32 v38, 0
    v_mov_b32 v39, 0
    v_mov_b32 v46, 0
    v_mov_b32 v47, 0
    s_mov_b32 exec_lo, -1
    s_mov_b32 s48, s46
    s_mov_b32 s49, 0
    v_mov_b32 v8, 0xff800000
    v_mov_b32 v9, 0xff800000
    v_mov_b32 v10, 0xff800000
    v_mov_b32 v11, 0xff800000
k2_fb_loop:
    buffer_load_dwordx4 v[208:211], v2, s[40:43], s48 offen
    buffer_load_dwordx4 v[212:215], v2, s[40:43], s48 offen offset:1024
    s_add_u32 s48, s48, 4096
    s_waitcnt vmcnt(0)
    v_mfma_f32_32x32x16_bf16 v[112:127], v[208:211], v[16:19], 0
    v_mfma_f32_32x32x16_bf16 v[112:127], v[212:215], v[20:23], v[112:127]
    v_mfma_f32_32x32x16_bf16 v[128:143], v[208:211], v[24:27], 0
    v_mfma_f32_32x32x16_bf16 v[128:143], v[212:215], v[28:31], v[128:143]
    v_mfma_f32_32x32x16_bf16 v[224:239], v[208:211], v[32:35], 0
    v_mfma_f32_32x32x16_bf16 v[224:239], v[212:215], v[36:39], v[224:239]
    v_mfma_f32_32x32x16_bf16 v[48:63], v[208:211], v[40:43], 0
    v_mfma_f32_32x32x16_bf16 v[48:63], v[212:215], v[44:47], v[48:63]
    s_nop 5
    v_max3_f32 v8, v8, v112, v113
    v_max3_f32 v8, v8, v114, v115
    v_max3_f32 v8, v8, v116, v117
    v_max3_f32 v8, v8, v118, v119
    v_max3_f32 v8, v8, v120, v121
    v_max3_f32 v8, v8, v122, v123
    v_max3_f32 v8, v8, v124, v125
    v_max3_f32 v8, v8, v126, v127
    v_max3_f32 v9, v9, v128, v129
    v_max3_f32 v9, v9, v130, v131
    v_max3_f32 v9, v9, v132, v133
    v_max3_f32 v9, v9, v134, v135
    v_max3_f32 v9, v9, v136, v137
    v_max3_f32 v9, v9, v138, v139
    v_max3_f32 v9, v9, v140, v141
    v_max3_f32 v9, v9, v142, v143
    v_max3_f32 v10, v10, v224, v225
    v_max3_f32 v10, v10, v226, v227
    v_max3_f32 v10, v10, v228, v229
    v_max3_f32 v10, v10, v230, v231
    v_max3_f32 v10, v10, v232, v233
    v_max3_f32 v10, v10, v234, v235
    v_max3_f32 v10, v10, v236, v237
    v_max3_f32 v10, v10, v238, v239
    v_max3_f32 v11, v11, v48, v49
    v_max3_f32 v11, v11, v50, v51
    v_max3_f32 v11, v11, v52, v53
    v_max3_f32 v11, v11, v54, v55
    v_max3_f32 v11, v11, v56, v57
    v_max3_f32 v11, v11, v58, v59
    v_max3_f32 v11, v11, v60, v61
    v_max3_f32 v11, v11, v62, v63
    s_add_u32 s49, s49, 1
    s_cmp_lt_u32 s49, 16
    s_cbranch_scc1 k2_fb_loop
    v_mov_b32 v12, v8
    v_mov_b32 v13, v9
    v_mov_b32 v14, v10
    v_mov_b32 v15, v11
    s_nop 0
    v_permlane32_swap_b32 v8, v12
    v_permlane32_swap_b32 v9, v13
    v_permlane32_swap_b32 v10, v14
    v_permlane32_swap_b32 v11, v15
    v_max_f32 v8, v8, v12
    v_max_f32 v9, v9, v13
    v_max_f32 v10, v10, v14
    v_max_f32 v11, v11, v15
    v_lshlrev_b32 v251, 2, v0
    s_lshl_b32 s62, s3, 10
    s_xor_b32 s61, s6, 0
    s_lshl_b32 s61, s61, 8
    s_add_u32 s61, s61, 98560
    v_add_u32 v12, s61, v251
    v_add_u32 v252, s62, v12
    ds_write_b32 v252, v8
    s_xor_b32 s61, s6, 1
    s_lshl_b32 s61, s61, 8
    s_add_u32 s61, s61, 98560
    v_add_u32 v13, s61, v251
    v_add_u32 v252, s62, v13
    ds_write_b32 v252, v9
    s_xor_b32 s61, s6, 2
    s_lshl_b32 s61, s61, 8
    s_add_u32 s61, s61, 98560
    v_add_u32 v14, s61, v251
    v_add_u32 v252, s62, v14
    ds_write_b32 v252, v10
    s_xor_b32 s61, s6, 3
    s_lshl_b32 s61, s61, 8
    s_add_u32 s61, s61, 98560
    v_add_u32 v15, s61, v251
    v_add_u32 v252, s62, v15
    ds_write_b32 v252, v11
    s_waitcnt lgkmcnt(0)
    s_barrier
    ds_read_b32 v112, v12 offset:0
    ds_read_b32 v113, v12 offset:1024
    ds_read_b32 v114, v12 offset:2048
    ds_read_b32 v115, v12 offset:3072
    s_waitcnt lgkmcnt(0)
    v_max3_f32 v8, v112, v113, v114
    v_max_f32 v8, v8, v115
    ds_read_b32 v116, v13 offset:0
    ds_read_b32 v117, v13 offset:1024
    ds_read_b32 v118, v13 offset:2048
    ds_read_b32 v119, v13 offset:3072
    s_waitcnt lgkmcnt(0)
    v_max3_f32 v9, v116, v117, v118
    v_max_f32 v9, v9, v119
    ds_read_b32 v120, v14 offset:0
    ds_read_b32 v121, v14 offset:1024
    ds_read_b32 v122, v14 offset:2048
    ds_read_b32 v123, v14 offset:3072
    s_waitcnt lgkmcnt(0)
    v_max3_f32 v10, v120, v121, v122
    v_max_f32 v10, v10, v123
    ds_read_b32 v124, v15 offset:0
    ds_read_b32 v125, v15 offset:1024
    ds_read_b32 v126, v15 offset:2048
    ds_read_b32 v127, v15 offset:3072
    s_waitcnt lgkmcnt(0)
    v_max3_f32 v11, v124, v125, v126
    v_max_f32 v11, v11, v127
    v_sub_f32 v8, 0, v8
    v_sub_f32 v9, 0, v9
    v_sub_f32 v10, 0, v10
    v_sub_f32 v11, 0, v11
    v_and_b32 v144, s72, v8
    v_and_b32 v146, s72, v9
    v_and_b32 v148, s72, v10
    v_and_b32 v150, s72, v11
    v_sub_f32 v8, v8, v144
    v_sub_f32 v9, v9, v146
    v_sub_f32 v10, v10, v148
    v_sub_f32 v11, v11, v150
    v_and_b32 v145, s72, v8
    v_and_b32 v147, s72, v9
    v_and_b32 v149, s72, v10
    v_and_b32 v151, s72, v11
    v_sub_f32 v8, v8, v145
    v_sub_f32 v9, v9, v147
    v_sub_f32 v10, v10, v149
    v_sub_f32 v11, v11, v151
    s_mov_b32 exec_lo, 0
    v_perm_b32 v22, v145, v144, s73
    v_lshrrev_b32 v23, 16, v8
    v_perm_b32 v30, v147, v146, s73
    v_lshrrev_b32 v31, 16, v9
    v_perm_b32 v38, v149, v148, s73
    v_lshrrev_b32 v39, 16, v10
    v_perm_b32 v46, v151, v150, s73
    v_lshrrev_b32 v47, 16, v11
    s_mov_b32 exec_lo, -1
k2_last:
    s_branch k2_restart
.section .rodata,"a"
.p2align 6
.amdhsa_kernel k1_kernel
  .amdhsa_next_free_vgpr 252
  .amdhsa_next_free_sgpr 102
  .amdhsa_accum_offset 252
  .amdhsa_group_segment_fixed_size 0
  .amdhsa_kernarg_size 96
  .amdhsa_user_sgpr_count 2
  .amdhsa_user_sgpr_kernarg_segment_ptr 1
  .amdhsa_system_sgpr_workgroup_id_x 1
  .amdhsa_float_denorm_mode_32 3
.end_amdhsa_kernel
.section .rodata,"a"
.p2align 6
.amdhsa_kernel k2_kernel
  .amdhsa_next_free_vgpr 512
  .amdhsa_next_free_sgpr 102
  .amdhsa_accum_offset 256
  .amdhsa_group_segment_fixed_size 0
  .amdhsa_kernarg_size 96
  .amdhsa_user_sgpr_count 2
  .amdhsa_user_sgpr_kernarg_segment_ptr 1
  .amdhsa_system_sgpr_workgroup_id_x 1
  .amdhsa_float_denorm_mode_32 3
.end_amdhsa_kernel
```
